```python
import torch

def _softmax(x, axis=-1):
    return torch.softmax(x, dim=axis)
def _gelu(x):
    return torch.nn.functional.gelu(x, approximate="tanh")
def _silu(x):
    return torch.nn.functional.silu(x)
def _sigmoid(x):
    return torch.sigmoid(x)
def _layernorm(x, axis=-1, eps=1e-5):
    m = x.mean(dim=axis, keepdim=True)
    v = x.var(dim=axis, keepdim=True, unbiased=False)
    return (x - m) / torch.sqrt(v + eps)
def _scatter_add(tgt, idx, src, axis=0):
    return tgt.clone().index_add_(axis, idx, src)
def _segment_sum(src, seg, n):
    out = torch.zeros((n,) + src.shape[1:], dtype=src.dtype)
    return out.index_add_(0, seg, src)
def _pad(x, pw):
    flat = tuple(v for pair in reversed(pw) for v in pair)
    return torch.nn.functional.pad(x, flat)

kernel_name = 'interleave_layers__grouped_kv_mqa__glu_gated_bilinear__prompt'

def setup_inputs():

    _w = (lambda a: (lambda t: t.to(torch.bfloat16) if t.is_floating_point() else t)(torch.as_tensor(a)))
    def _A_setup():
        B, S, D, H = 1, 2048, 512, 32
        Dh = D // H
        return {
            "x": _w((lambda *s: torch.randn(*s, dtype=torch.bfloat16) * 0.05)(B, S, D)),
            "wq": _w((lambda *s: torch.randn(*s, dtype=torch.bfloat16) * 0.05)(D, H * Dh)),
            "wk": _w((lambda *s: torch.randn(*s, dtype=torch.bfloat16) * 0.05)(D, Dh)),
            "wv": _w((lambda *s: torch.randn(*s, dtype=torch.bfloat16) * 0.05)(D, Dh)),
            "wo": _w((lambda *s: torch.randn(*s, dtype=torch.bfloat16) * 0.05)(H * Dh, D)),
        }
    _A_in = _A_setup()

    def _B_setup():
        B, S, D, F = 1, 2048, 512, 1792
        return {
            "x": _w((lambda *s: torch.randn(*s, dtype=torch.bfloat16) * 0.05)(B, S, D)),
            "w_gate": _w((lambda *s: torch.randn(*s, dtype=torch.bfloat16) * 0.4)(D, F) * (D ** -0.5)),
            "w_up": _w((lambda *s: torch.randn(*s, dtype=torch.bfloat16) * 0.4)(D, F) * (D ** -0.5)),
            "w_down": _w((lambda *s: torch.randn(*s, dtype=torch.bfloat16) * 0.4)(F, D) * (F ** -0.5)),
        }
    _B_in = _B_setup()

    return {
        "A_x": _A_in["x"],
        "A_wq": _A_in["wq"],
        "A_wk": _A_in["wk"],
        "A_wv": _A_in["wv"],
        "A_wo": _A_in["wo"],
        "B_x": _B_in["x"],
        "B_w_gate": _B_in["w_gate"],
        "B_w_up": _B_in["w_up"],
        "B_w_down": _B_in["w_down"],
    }

def reference(A_x, A_wq, A_wk, A_wv, A_wo, B_x, B_w_gate, B_w_up, B_w_down):
    def _A_ref(x, wq, wk, wv, wo):
        B, S, D = x.shape
        H = 32
        Dh = D // H
        q = (lambda x, *d: x.permute(*d))((x @ wq).reshape(B, S, H, Dh), 0, 2, 1, 3)
        k = x @ wk
        v = x @ wv
        scores = torch.einsum("bhqd,bkd->bhqk", q, k) * (Dh ** -0.5)
        p = _softmax(scores, axis=-1)
        o = torch.einsum("bhqk,bkd->bhqd", p, v)
        return (lambda x, *d: x.permute(*d))(o, 0, 2, 1, 3).reshape(B, S, H * Dh) @ wo

    def _B_ref(x, w_gate, w_up, w_down):
        g = torch.einsum("bsd,df->bsf", x, w_gate)
        u = torch.einsum("bsd,df->bsf", x, w_up)
        h = g * u
        return torch.einsum("bsf,fd->bsd", h, w_down)

    x = A_x
    x = x + _A_ref(_layernorm(x, axis=-1), A_wq, A_wk, A_wv, A_wo)
    x = x + _B_ref(_layernorm(x, axis=-1), B_w_gate, B_w_up, B_w_down)
    x = x + _A_ref(_layernorm(x, axis=-1), A_wq, A_wk, A_wv, A_wo)
    x = x + _B_ref(_layernorm(x, axis=-1), B_w_gate, B_w_up, B_w_down)
    return x
```

```asm
; @launch grid=(256,1,1) block=(512,1,1) lds=163840
.amdgcn_target "amdgcn-amd-amdhsa--gfx950"
.text
.globl interleave_layers__grouped_kv_mqa__glu_gated_bilinear__prompt_kernel
.p2align 8
.type interleave_layers__grouped_kv_mqa__glu_gated_bilinear__prompt_kernel,@function
interleave_layers__grouped_kv_mqa__glu_gated_bilinear__prompt_kernel:
    s_cmp_ge_u32 s2, 256
    s_cbranch_scc1 L_exit
    s_load_dwordx2 s[4:5], s[0:1], 0
    s_load_dwordx2 s[24:25], s[0:1], 8
    s_load_dwordx4 s[16:19], s[0:1], 16
    s_load_dwordx2 s[8:9], s[0:1], 88
    s_load_dwordx2 s[64:65], s[0:1], 80
    s_getpc_b64 s[22:23]
    s_lshr_b32 s35, s2, 3
    s_mul_i32 s35, s35, 1152
    v_and_b32 v2, 15, v0
    v_lshl_add_u32 v2, v2, 7, s35
    v_min_u32 v2, 34324, v2
    global_load_dword v135, v2, s[22:23]
    v_and_b32 v1, 63, v0
    v_lshrrev_b32 v2, 6, v0
    v_lshlrev_b32 v1, 4, v1
    v_readfirstlane_b32 s3, v2
    s_and_b32 s28, s2, 7
    s_lshl_b32 s28, s28, 5
    s_lshr_b32 s29, s2, 3
    s_add_u32 s28, s28, s29
    s_mov_b32 s6, 2097152
    s_mov_b32 s7, 0x00020000
    s_mov_b32 s26, 524288
    s_mov_b32 s27, 0x00020000
    s_mov_b32 s10, 0x10000000
    s_mov_b32 s11, 0x00020000
    s_mov_b32 s46, 16384
    s_mov_b32 s47, 0x00020000
    s_lshr_b32 s12, s28, 3
    s_and_b32 s13, s28, 7
    v_bfe_u32 v2, v0, 3, 3
    v_bfe_u32 v3, v0, 4, 1
    v_lshlrev_b32 v3, 6, v3
    v_and_b32 v5, 7, v0
    v_lshlrev_b32 v5, 4, v5
    v_xor_b32 v3, v3, v5
    v_lshl_add_u32 v2, v2, 10, v3
    s_lshl_b32 s14, s12, 1
    s_add_u32 s14, s14, s3
    s_and_b32 s14, s14, 7
    s_lshl_b32 s22, s13, 7
    s_lshl_b32 s15, s14, 16
    s_add_u32 s22, s22, s15
    s_lshl_b32 s23, s14, 13
    s_add_u32 s14, s13, s3
    s_and_b32 s14, s14, 7
    s_lshl_b32 s20, s12, 16
    s_lshl_b32 s21, s14, 13
    s_add_u32 s20, s20, s21
    s_and_b32 s14, s14, 1
    s_lshl_b32 s14, s14, 7
    v_xor_b32 v5, s14, v1
    s_lshl_b32 s30, s28, 2
    s_add_u32 s30, s30, 1572864
    s_lshr_b32 s56, s28, 5
    s_lshl_b32 s56, s56, 7
    s_bfe_u32 s36, s28, 0x20003
    s_lshl_b32 s36, s36, 4
    s_add_u32 s56, s56, s36
    s_add_u32 s56, s56, 1576960
    s_cmp_lg_u32 s3, 0
    s_cbranch_scc1 M_noboot
    v_mov_b32 v6, s30
    s_lshr_b32 s36, s28, 3
    s_lshl_b32 s36, s36, 8
    s_add_u32 s36, s36, 1581056
    s_and_b32 s38, s28, 7
    s_lshl_b32 s38, s38, 2
    s_add_u32 s37, s36, s38
    s_add_u32 s37, s37, 32
    v_writelane_b32 v6, s37, 1
    s_and_b32 s38, s28, 4
    s_lshl_b32 s38, s38, 1
    s_add_u32 s37, s36, s38
    v_writelane_b32 v6, s37, 2
    s_add_u32 s37, s37, 4
    v_writelane_b32 v6, s37, 3
    s_add_u32 s37, s37, 8188
    v_writelane_b32 v6, s37, 4
    s_add_u32 s37, s37, 4
    v_writelane_b32 v6, s37, 5
    s_add_u32 s37, s56, s38
    v_writelane_b32 v6, s37, 6
    s_add_u32 s37, s37, 4
    v_writelane_b32 v6, s37, 7
    v_mov_b32 v7, 0
    s_and_b32 s37, s28, 3
    s_cselect_b32 s38, 3, 0xff
    s_mov_b32 exec_lo, s38
    s_mov_b32 exec_hi, 0
    s_waitcnt lgkmcnt(0)
    buffer_store_dword v7, v6, s[8:11], 0 offen sc1
    s_mov_b64 exec, -1
M_noboot:
    s_waitcnt lgkmcnt(0)
    s_and_b32 s36, s28, 3
    s_cbranch_scc1 Q0_nokv
    s_cmp_lt_u32 s3, 4
    s_cselect_b32 s44, s16, s18
    s_cselect_b32 s45, s17, s19
    s_lshl_b32 s17, s3, 12
    s_add_u32 m0, s17, 131072
    s_and_b32 s18, s17, 0x3fff
    buffer_load_dwordx4 v1, s[44:47], s18 offen offset:0 lds
    buffer_load_dwordx4 v1, s[44:47], s18 offen offset:1024 lds
    buffer_load_dwordx4 v1, s[44:47], s18 offen offset:2048 lds
    buffer_load_dwordx4 v1, s[44:47], s18 offen offset:3072 lds
Q0_nokv:
    s_add_u32 m0, s23, 0
    s_nop 0
    buffer_load_dwordx4 v2, s[24:27], s22 offen lds
    s_add_u32 m0, s21, 65536
    v_xor_b32 v3, 0, v5
    buffer_load_dwordx4 v3, s[4:7], s20 offen lds
    s_add_u32 m0, s23, 1024
    s_add_u32 s22, s22, 8192
    buffer_load_dwordx4 v2, s[24:27], s22 offen lds
    s_add_u32 m0, s21, 66560
    v_xor_b32 v3, 16, v5
    s_add_u32 s20, s20, 1024
    buffer_load_dwordx4 v3, s[4:7], s20 offen lds
    s_add_u32 m0, s23, 2048
    s_add_u32 s22, s22, 8192
    buffer_load_dwordx4 v2, s[24:27], s22 offen lds
    s_add_u32 m0, s21, 67584
    v_xor_b32 v3, 32, v5
    s_add_u32 s20, s20, 1024
    buffer_load_dwordx4 v3, s[4:7], s20 offen lds
    s_mov_b32 s29, 0
    s_mov_b32 s31, 16777216
    s_mov_b32 s32, 0
    s_mov_b32 s33, 0
    s_getreg_b32 s34, hwreg(HW_REG_XCC_ID)
    s_and_b32 s34, s34, 7
    s_mul_i32 s35, s34, s34
    s_lshl_b32 s35, s35, 15
    s_lshl_b32 s34, s34, 6
    s_add_u32 s34, s34, s35
    s_add_u32 s34, s34, 1
    s_lshr_b32 s62, s28, 3
    s_lshl_b32 s62, s62, 1
    s_lshr_b32 s36, s3, 2
    s_add_u32 s62, s62, s36
    s_lshl_b32 s63, s36, 2
    s_and_b32 s37, s28, 7
    s_xor_b32 s63, s63, s37
    s_lshl_b32 s52, s3, 10
    s_lshr_b32 s50, s28, 3
    s_mul_i32 s50, s50, 6
    s_and_b32 s13, s28, 7
    s_add_u32 s50, s50, s13
    s_sub_u32 s50, s50, 1
    s_lshr_b32 s13, s13, 2
    s_sub_u32 s50, s50, s13
    s_cmp_lt_u32 s3, 4
    s_cselect_b32 s16, 48, 56
    s_cmp_lt_u32 s50, 112
    s_cselect_b32 s16, s16, 64
    s_cmp_lt_u32 s50, 168
    s_cselect_b32 s16, s16, 32
    s_load_dwordx2 s[40:41], s[0:1], s16
    s_mov_b32 s42, 1835008
    s_cselect_b32 s42, s42, 524288
    s_mov_b32 s43, 0x00020000
    v_bfe_u32 v148, v0, 3, 3
    v_and_b32 v149, 7, v0
    v_lshlrev_b32 v149, 4, v149
    s_cmp_lt_u32 s50, 112
    s_cbranch_scc0 PS_a
    s_movk_i32 s17, 3584
    v_mul_lo_u32 v136, v148, s17
    s_and_b32 s17, s50, 3
    s_lshl_b32 s17, s17, 4
    s_and_b32 s18, s3, 3
    s_add_u32 s17, s17, s18
    s_mul_i32 s17, s17, 28672
    s_lshr_b32 s18, s50, 2
    s_lshl_b32 s18, s18, 7
    s_add_u32 s17, s17, s18
    s_mov_b32 s48, 114688
    s_branch PS_b
PS_a:
    v_lshlrev_b32 v136, 10, v148
    s_sub_u32 s51, s50, 112
    s_cmp_lt_u32 s50, 168
    s_cselect_b32 s17, 0, 56
    s_sub_u32 s51, s51, s17
    s_lshr_b32 s17, s51, 3
    s_lshl_b32 s17, s17, 5
    s_add_u32 s17, s17, s3
    s_lshl_b32 s17, s17, 13
    s_and_b32 s18, s51, 7
    s_lshl_b32 s18, s18, 7
    s_add_u32 s17, s17, s18
    s_mov_b32 s48, 65536
PS_b:
    v_add3_u32 v136, v136, v149, s17
    v_mov_b32 v144, 1879048192
    s_lshr_b32 s14, s3, 2
    s_and_b32 s15, s3, 3
    v_mov_b32 v128, 0x3f803f80
    v_mov_b32 v129, 0x3f803f80
    v_mov_b32 v130, 0x3f803f80
    v_mov_b32 v131, 0x3f803f80
    v_mov_b32 v132, 0
    v_mov_b32 v133, 0
    v_lshrrev_b32 v4, 9, v1
    v_lshlrev_b32 v4, 4, v4
    v_bfe_u32 v8, v0, 2, 2
    v_bfe_u32 v15, v0, 5, 1
    v_lshl_add_u32 v9, v15, 3, v8
    v_and_b32 v10, 3, v0
    v_lshlrev_b32 v10, 3, v10
    v_bfe_u32 v11, v0, 4, 1
    v_lshl_add_u32 v12, v11, 5, v10
    v_lshl_add_u32 v12, v9, 7, v12
    v_bfe_u32 v13, v0, 3, 1
    v_lshl_add_u32 v12, v13, 6, v12
    s_lshl_b32 s18, s14, 6
    v_xor_b32 v12, s18, v12
    s_lshl_b32 s17, s15, 14
    v_add_u32 v12, s17, v12
    v_xor_b32 v13, 64, v12
    v_lshlrev_b32 v14, 14, v11
    v_lshl_add_u32 v14, v9, 5, v14
    v_add_u32 v14, v14, v10
    s_lshl_b32 s17, s15, 12
    s_add_u32 s17, s17, 131072
    v_add_u32 v14, s17, v14
    v_and_b32 v8, 15, v0
    v_xor_b32 v8, v8, v15
    v_lshlrev_b32 v8, 4, v8
    v_and_b32 v9, 31, v0
    v_lshl_add_u32 v8, v9, 10, v8
    s_lshl_b32 s17, s14, 15
    s_lshl_b32 s18, s15, 8
    s_add_u32 s17, s17, s18
    s_add_u32 s17, s17, 65536
    s_and_b32 s16, s28, 7
    s_lshl_b32 s16, s16, 7
    s_lshl_b32 s18, s15, 5
    s_add_u32 s16, s16, s18
    v_xor_b32 v48, s16, v8
    s_lshl_b32 s18, s14, 15
    s_add_u32 s18, s18, 65536
    v_add_u32 v48, s18, v48
    v_add_u32 v8, s17, v8
    v_xor_b32 v49, 32, v8
    v_xor_b32 v50, 64, v8
    v_xor_b32 v51, 96, v8
    v_xor_b32 v52, 128, v8
    v_xor_b32 v53, 160, v8
    v_xor_b32 v54, 192, v8
    v_xor_b32 v55, 224, v8
    s_mov_b32 s44, s64
    s_mov_b32 s45, s65
    s_mov_b32 s46, 256
    s_mov_b32 s47, 0x00020000
    s_cmp_lg_u32 s3, 0
    s_cbranch_scc1 Q0_atd
    v_mov_b32 v3, s34
    v_mov_b32 v7, 0
    s_and_b32 s17, s28, 0xe0
    s_mov_b64 exec, 1
    s_waitcnt vmcnt(6)
    buffer_atomic_add v3, v7, s[44:47], s17 offen sc1
    s_mov_b64 exec, -1
Q0_atd:
    s_add_u32 m0, s23, 3072
    s_add_u32 s22, s22, 8192
    buffer_load_dwordx4 v2, s[24:27], s22 offen lds
    s_add_u32 m0, s21, 68608
    v_xor_b32 v3, 48, v5
    s_add_u32 s20, s20, 1024
    buffer_load_dwordx4 v3, s[4:7], s20 offen lds
    s_add_u32 m0, s23, 4096
    s_add_u32 s22, s22, 8192
    buffer_load_dwordx4 v2, s[24:27], s22 offen lds
    s_add_u32 m0, s21, 69632
    v_xor_b32 v3, 64, v5
    s_add_u32 s20, s20, 1024
    buffer_load_dwordx4 v3, s[4:7], s20 offen lds
    s_add_u32 m0, s23, 5120
    s_add_u32 s22, s22, 8192
    buffer_load_dwordx4 v2, s[24:27], s22 offen lds
    s_add_u32 m0, s21, 70656
    v_xor_b32 v3, 80, v5
    s_add_u32 s20, s20, 1024
    buffer_load_dwordx4 v3, s[4:7], s20 offen lds
    s_add_u32 m0, s23, 6144
    s_add_u32 s22, s22, 8192
    buffer_load_dwordx4 v2, s[24:27], s22 offen lds
    s_add_u32 m0, s21, 71680
    v_xor_b32 v3, 96, v5
    s_add_u32 s20, s20, 1024
    buffer_load_dwordx4 v3, s[4:7], s20 offen lds
    s_add_u32 m0, s23, 7168
    s_add_u32 s22, s22, 8192
    buffer_load_dwordx4 v2, s[24:27], s22 offen lds
    s_add_u32 m0, s21, 72704
    v_xor_b32 v3, 112, v5
    s_add_u32 s20, s20, 1024
    buffer_load_dwordx4 v3, s[4:7], s20 offen lds
    s_load_dwordx2 s[24:25], s[0:1], 72
    s_mov_b32 s26, 2097152
    v_and_b32 v2, 7, v0
    v_lshlrev_b32 v2, 5, v2
    s_waitcnt vmcnt(0) lgkmcnt(0)
    s_cmp_lg_u32 s3, 7
    s_cbranch_scc1 Q0_w7
    buffer_load_dword v135, v2, s[44:47], 0 offen sc1
Q0_w7:
    s_barrier
    ds_read_b128 v[16:19], v8
    ds_read_b128 v[20:23], v49
    ds_read_b128 v[24:27], v50
    ds_read_b128 v[28:31], v51
    ds_read_b128 v[32:35], v52
    ds_read_b128 v[36:39], v53
    ds_read_b128 v[40:43], v54
    ds_read_b128 v[44:47], v55
    ds_read_b128 v[252:255], v48
    s_and_b32 s17, s28, 3
    s_cselect_b32 s64, 0, 1
    s_cbranch_scc0 Q0_nostg
    s_add_u32 m0, s52, 135168
    s_mul_i32 s17, s48, 0
    buffer_load_dwordx4 v136, s[40:43], s17 offen lds
    s_add_u32 m0, s52, 143360
    s_mul_i32 s17, s48, 1
    buffer_load_dwordx4 v136, s[40:43], s17 offen lds
    s_add_u32 m0, s52, 151552
    s_mul_i32 s17, s48, 2
    buffer_load_dwordx4 v136, s[40:43], s17 offen lds
Q0_nostg:
    s_cmp_lg_u32 s63, 0
    s_cbranch_scc1 Q0_np2
    s_setprio 2
Q0_np2:
    v_mov_b32 v96, 0
    v_mov_b32 v97, 0
    v_mov_b32 v98, 0
    v_mov_b32 v99, 0
    ds_read_b64_tr_b16 v[156:157], v12 offset:0
    ds_read_b64_tr_b16 v[158:159], v12 offset:512
    s_waitcnt lgkmcnt(10)
    v_dot2c_f32_bf16 v132, v16, v128
    v_dot2c_f32_bf16 v133, v16, v16
    s_lshl_b32 s52, s3, 10
    s_and_b32 s13, s28, 7
    v_dot2c_f32_bf16 v132, v17, v128
    v_dot2c_f32_bf16 v133, v17, v17
    s_mul_i32 s37, s13, 229376
    s_mul_i32 s18, s3, 28672
    v_dot2c_f32_bf16 v132, v18, v128
    v_dot2c_f32_bf16 v133, v18, v18
    s_add_u32 s37, s37, s18
    s_add_u32 s37, s37, 6291456
    v_dot2c_f32_bf16 v132, v19, v128
    v_dot2c_f32_bf16 v133, v19, v19
    s_and_b32 s36, s28, 15
    s_mul_i32 s36, s36, 7
    ds_read_b64_tr_b16 v[160:161], v12 offset:2048
    ds_read_b64_tr_b16 v[162:163], v12 offset:2560
    s_waitcnt lgkmcnt(11)
    v_dot2c_f32_bf16 v132, v20, v128
    v_dot2c_f32_bf16 v133, v20, v20
    s_add_u32 s36, s36, s3
    s_lshr_b32 s58, s28, 4
    v_dot2c_f32_bf16 v132, v21, v128
    v_dot2c_f32_bf16 v133, v21, v21
    s_mul_i32 s58, s58, 224
    s_add_u32 s58, s58, s36
    v_dot2c_f32_bf16 v132, v22, v128
    v_dot2c_f32_bf16 v133, v22, v22
    s_lshl_b32 s58, s58, 11
    s_add_u32 s58, s58, 25165824
    v_dot2c_f32_bf16 v132, v23, v128
    v_dot2c_f32_bf16 v133, v23, v23
    s_lshl_b32 s36, s36, 15
    s_add_u32 s36, s36, 2097152
    ds_read_b64_tr_b16 v[164:165], v12 offset:4096
    ds_read_b64_tr_b16 v[166:167], v12 offset:4608
    s_waitcnt lgkmcnt(12)
    v_dot2c_f32_bf16 v132, v24, v128
    v_dot2c_f32_bf16 v133, v24, v24
    s_cmp_eq_u32 s3, 7
    s_cselect_b32 s36, s37, s36
    v_dot2c_f32_bf16 v132, v25, v128
    v_dot2c_f32_bf16 v133, v25, v25
    s_lshl_b32 s39, s13, 1
    s_lshr_b32 s18, s3, 2
    v_dot2c_f32_bf16 v132, v26, v128
    v_dot2c_f32_bf16 v133, v26, v26
    s_add_u32 s39, s39, s18
    s_lshl_b32 s39, s39, 15
    v_dot2c_f32_bf16 v132, v27, v128
    v_dot2c_f32_bf16 v133, v27, v27
    s_and_b32 s18, s3, 3
    s_lshl_b32 s18, s18, 13
    ds_read_b64_tr_b16 v[168:169], v12 offset:6144
    ds_read_b64_tr_b16 v[170:171], v12 offset:6656
    s_waitcnt lgkmcnt(13)
    v_dot2c_f32_bf16 v132, v28, v128
    v_dot2c_f32_bf16 v133, v28, v28
    s_add_u32 s39, s39, s18
    s_add_u32 s38, s39, 524288
    v_dot2c_f32_bf16 v132, v29, v128
    v_dot2c_f32_bf16 v133, v29, v29
    s_xor_b32 s54, s38, 0x8000
    s_lshl_b32 s55, s62, 15
    v_dot2c_f32_bf16 v132, v30, v128
    v_dot2c_f32_bf16 v133, v30, v30
    s_add_u32 s55, s55, s18
    s_add_u32 s53, s52, 18874368
    v_dot2c_f32_bf16 v132, v31, v128
    v_dot2c_f32_bf16 v133, v31, v31
    s_lshr_b32 s59, s28, 5
    s_lshl_b32 s59, s59, 13
    ds_read_b64_tr_b16 v[172:173], v12 offset:8192
    ds_read_b64_tr_b16 v[174:175], v12 offset:8704
    s_waitcnt lgkmcnt(14)
    v_dot2c_f32_bf16 v132, v32, v128
    v_dot2c_f32_bf16 v133, v32, v32
    s_mov_b32 s60, 1581056
    s_mov_b32 s35, 16777216
    v_dot2c_f32_bf16 v132, v33, v128
    v_dot2c_f32_bf16 v133, v33, v33
    s_and_b32 s17, s3, 3
    s_lshl_b32 s18, s13, 2
    v_dot2c_f32_bf16 v132, v34, v128
    v_dot2c_f32_bf16 v133, v34, v34
    s_add_u32 s17, s17, s18
    s_lshl_b32 s61, s62, 5
    v_dot2c_f32_bf16 v132, v35, v128
    v_dot2c_f32_bf16 v133, v35, v35
    s_add_u32 s61, s61, s17
    s_lshl_b32 s61, s61, 10
    ds_read_b64_tr_b16 v[176:177], v12 offset:10240
    ds_read_b64_tr_b16 v[178:179], v12 offset:10752
    s_waitcnt lgkmcnt(15)
    v_dot2c_f32_bf16 v132, v36, v128
    v_dot2c_f32_bf16 v133, v36, v36
    v_dot2c_f32_bf16 v132, v37, v128
    v_dot2c_f32_bf16 v133, v37, v37
    v_dot2c_f32_bf16 v132, v38, v128
    v_dot2c_f32_bf16 v133, v38, v38
    v_dot2c_f32_bf16 v132, v39, v128
    v_dot2c_f32_bf16 v133, v39, v39
    ds_read_b64_tr_b16 v[180:181], v12 offset:12288
    ds_read_b64_tr_b16 v[182:183], v12 offset:12800
    s_waitcnt lgkmcnt(15)
    v_dot2c_f32_bf16 v132, v40, v128
    v_dot2c_f32_bf16 v133, v40, v40
    v_dot2c_f32_bf16 v132, v41, v128
    v_dot2c_f32_bf16 v133, v41, v41
    v_dot2c_f32_bf16 v132, v42, v128
    v_dot2c_f32_bf16 v133, v42, v42
    v_dot2c_f32_bf16 v132, v43, v128
    v_dot2c_f32_bf16 v133, v43, v43
    ds_read_b64_tr_b16 v[184:185], v12 offset:14336
    ds_read_b64_tr_b16 v[186:187], v12 offset:14848
    s_waitcnt lgkmcnt(15)
    v_dot2c_f32_bf16 v132, v44, v128
    v_dot2c_f32_bf16 v133, v44, v44
    v_dot2c_f32_bf16 v132, v45, v128
    v_dot2c_f32_bf16 v133, v45, v45
    v_dot2c_f32_bf16 v132, v46, v128
    v_dot2c_f32_bf16 v133, v46, v46
    v_dot2c_f32_bf16 v132, v47, v128
    v_dot2c_f32_bf16 v133, v47, v47
    s_cmp_lg_u32 s63, 0
    s_cbranch_scc1 Q0_v1
    ds_read_b64_tr_b16 v[220:221], v14 offset:0
    ds_read_b64_tr_b16 v[222:223], v14 offset:128
    s_waitcnt lgkmcnt(15)
    v_dot2c_f32_bf16 v96, v156, v128
    v_dot2c_f32_bf16 v99, v157, v128
    v_dot2c_f32_bf16 v96, v158, v128
    v_dot2c_f32_bf16 v99, v159, v128
    ds_read_b64_tr_b16 v[224:225], v14 offset:512
    ds_read_b64_tr_b16 v[226:227], v14 offset:640
    s_waitcnt lgkmcnt(15)
    v_dot2c_f32_bf16 v96, v160, v128
    v_dot2c_f32_bf16 v99, v161, v128
    v_dot2c_f32_bf16 v96, v162, v128
    v_dot2c_f32_bf16 v99, v163, v128
    ds_read_b64_tr_b16 v[228:229], v14 offset:1024
    ds_read_b64_tr_b16 v[230:231], v14 offset:1152
    s_waitcnt lgkmcnt(15)
    v_dot2c_f32_bf16 v96, v164, v128
    v_dot2c_f32_bf16 v99, v165, v128
    v_dot2c_f32_bf16 v96, v166, v128
    v_dot2c_f32_bf16 v99, v167, v128
    ds_read_b64_tr_b16 v[232:233], v14 offset:1536
    ds_read_b64_tr_b16 v[234:235], v14 offset:1664
    s_waitcnt lgkmcnt(15)
    v_dot2c_f32_bf16 v96, v168, v128
    v_dot2c_f32_bf16 v99, v169, v128
    v_dot2c_f32_bf16 v96, v170, v128
    v_dot2c_f32_bf16 v99, v171, v128
    ds_read_b64_tr_b16 v[236:237], v14 offset:2048
    ds_read_b64_tr_b16 v[238:239], v14 offset:2176
    s_waitcnt lgkmcnt(15)
    v_dot2c_f32_bf16 v96, v172, v128
    v_dot2c_f32_bf16 v99, v173, v128
    v_dot2c_f32_bf16 v96, v174, v128
    v_dot2c_f32_bf16 v99, v175, v128
    ds_read_b64_tr_b16 v[240:241], v14 offset:2560
    ds_read_b64_tr_b16 v[242:243], v14 offset:2688
    s_waitcnt lgkmcnt(15)
    v_dot2c_f32_bf16 v96, v176, v128
    v_dot2c_f32_bf16 v99, v177, v128
    v_dot2c_f32_bf16 v96, v178, v128
    v_dot2c_f32_bf16 v99, v179, v128
    ds_read_b64_tr_b16 v[244:245], v14 offset:3072
    ds_read_b64_tr_b16 v[246:247], v14 offset:3200
    s_waitcnt lgkmcnt(15)
    v_dot2c_f32_bf16 v96, v180, v128
    v_dot2c_f32_bf16 v99, v181, v128
    v_dot2c_f32_bf16 v96, v182, v128
    v_dot2c_f32_bf16 v99, v183, v128
    ds_read_b64_tr_b16 v[248:249], v14 offset:3584
    ds_read_b64_tr_b16 v[250:251], v14 offset:3712
    s_waitcnt lgkmcnt(15)
    v_dot2c_f32_bf16 v96, v184, v128
    v_dot2c_f32_bf16 v99, v185, v128
    v_dot2c_f32_bf16 v96, v186, v128
    v_dot2c_f32_bf16 v99, v187, v128
    ds_read_b64_tr_b16 v[188:189], v13 offset:0
    ds_read_b64_tr_b16 v[190:191], v13 offset:512
    s_waitcnt lgkmcnt(15)
    v_dot2c_f32_bf16 v97, v220, v128
    v_dot2c_f32_bf16 v98, v221, v128
    v_dot2c_f32_bf16 v97, v222, v128
    v_dot2c_f32_bf16 v98, v223, v128
    ds_read_b64_tr_b16 v[192:193], v13 offset:2048
    ds_read_b64_tr_b16 v[194:195], v13 offset:2560
    s_waitcnt lgkmcnt(15)
    v_dot2c_f32_bf16 v97, v224, v128
    v_dot2c_f32_bf16 v98, v225, v128
    v_dot2c_f32_bf16 v97, v226, v128
    v_dot2c_f32_bf16 v98, v227, v128
    ds_read_b64_tr_b16 v[196:197], v13 offset:4096
    ds_read_b64_tr_b16 v[198:199], v13 offset:4608
    s_waitcnt lgkmcnt(15)
    v_dot2c_f32_bf16 v97, v228, v128
    v_dot2c_f32_bf16 v98, v229, v128
    v_dot2c_f32_bf16 v97, v230, v128
    v_dot2c_f32_bf16 v98, v231, v128
    ds_read_b64_tr_b16 v[200:201], v13 offset:6144
    ds_read_b64_tr_b16 v[202:203], v13 offset:6656
    s_waitcnt lgkmcnt(15)
    v_dot2c_f32_bf16 v97, v232, v128
    v_dot2c_f32_bf16 v98, v233, v128
    v_dot2c_f32_bf16 v97, v234, v128
    v_dot2c_f32_bf16 v98, v235, v128
    ds_read_b64_tr_b16 v[204:205], v13 offset:8192
    ds_read_b64_tr_b16 v[206:207], v13 offset:8704
    s_waitcnt lgkmcnt(15)
    v_dot2c_f32_bf16 v97, v236, v128
    v_dot2c_f32_bf16 v98, v237, v128
    v_dot2c_f32_bf16 v97, v238, v128
    v_dot2c_f32_bf16 v98, v239, v128
    ds_read_b64_tr_b16 v[208:209], v13 offset:10240
    ds_read_b64_tr_b16 v[210:211], v13 offset:10752
    s_waitcnt lgkmcnt(15)
    v_dot2c_f32_bf16 v97, v240, v128
    v_dot2c_f32_bf16 v98, v241, v128
    v_dot2c_f32_bf16 v97, v242, v128
    v_dot2c_f32_bf16 v98, v243, v128
    ds_read_b64_tr_b16 v[212:213], v13 offset:12288
    ds_read_b64_tr_b16 v[214:215], v13 offset:12800
    s_waitcnt lgkmcnt(15)
    v_dot2c_f32_bf16 v97, v244, v128
    v_dot2c_f32_bf16 v98, v245, v128
    v_dot2c_f32_bf16 v97, v246, v128
    v_dot2c_f32_bf16 v98, v247, v128
    ds_read_b64_tr_b16 v[216:217], v13 offset:14336
    ds_read_b64_tr_b16 v[218:219], v13 offset:14848
    s_waitcnt lgkmcnt(15)
    v_dot2c_f32_bf16 v97, v248, v128
    v_dot2c_f32_bf16 v98, v249, v128
    v_dot2c_f32_bf16 v97, v250, v128
    v_dot2c_f32_bf16 v98, v251, v128
    s_branch Q0_v2
Q0_v1:
    ds_read_b64_tr_b16 v[188:189], v13 offset:0
    ds_read_b64_tr_b16 v[190:191], v13 offset:512
    s_waitcnt lgkmcnt(15)
    v_dot2c_f32_bf16 v96, v156, v128
    v_dot2c_f32_bf16 v99, v157, v128
    v_dot2c_f32_bf16 v96, v158, v128
    v_dot2c_f32_bf16 v99, v159, v128
    ds_read_b64_tr_b16 v[192:193], v13 offset:2048
    ds_read_b64_tr_b16 v[194:195], v13 offset:2560
    s_waitcnt lgkmcnt(15)
    v_dot2c_f32_bf16 v96, v160, v128
    v_dot2c_f32_bf16 v99, v161, v128
    v_dot2c_f32_bf16 v96, v162, v128
    v_dot2c_f32_bf16 v99, v163, v128
    ds_read_b64_tr_b16 v[196:197], v13 offset:4096
    ds_read_b64_tr_b16 v[198:199], v13 offset:4608
    s_waitcnt lgkmcnt(15)
    v_dot2c_f32_bf16 v96, v164, v128
    v_dot2c_f32_bf16 v99, v165, v128
    v_dot2c_f32_bf16 v96, v166, v128
    v_dot2c_f32_bf16 v99, v167, v128
    ds_read_b64_tr_b16 v[200:201], v13 offset:6144
    ds_read_b64_tr_b16 v[202:203], v13 offset:6656
    s_waitcnt lgkmcnt(15)
    v_dot2c_f32_bf16 v96, v168, v128
    v_dot2c_f32_bf16 v99, v169, v128
    v_dot2c_f32_bf16 v96, v170, v128
    v_dot2c_f32_bf16 v99, v171, v128
    ds_read_b64_tr_b16 v[204:205], v13 offset:8192
    ds_read_b64_tr_b16 v[206:207], v13 offset:8704
    s_waitcnt lgkmcnt(15)
    v_dot2c_f32_bf16 v96, v172, v128
    v_dot2c_f32_bf16 v99, v173, v128
    v_dot2c_f32_bf16 v96, v174, v128
    v_dot2c_f32_bf16 v99, v175, v128
    ds_read_b64_tr_b16 v[208:209], v13 offset:10240
    ds_read_b64_tr_b16 v[210:211], v13 offset:10752
    s_waitcnt lgkmcnt(15)
    v_dot2c_f32_bf16 v96, v176, v128
    v_dot2c_f32_bf16 v99, v177, v128
    v_dot2c_f32_bf16 v96, v178, v128
    v_dot2c_f32_bf16 v99, v179, v128
    ds_read_b64_tr_b16 v[212:213], v13 offset:12288
    ds_read_b64_tr_b16 v[214:215], v13 offset:12800
    s_waitcnt lgkmcnt(15)
    v_dot2c_f32_bf16 v96, v180, v128
    v_dot2c_f32_bf16 v99, v181, v128
    v_dot2c_f32_bf16 v96, v182, v128
    v_dot2c_f32_bf16 v99, v183, v128
    ds_read_b64_tr_b16 v[216:217], v13 offset:14336
    ds_read_b64_tr_b16 v[218:219], v13 offset:14848
    s_waitcnt lgkmcnt(15)
    v_dot2c_f32_bf16 v96, v184, v128
    v_dot2c_f32_bf16 v99, v185, v128
    v_dot2c_f32_bf16 v96, v186, v128
    v_dot2c_f32_bf16 v99, v187, v128
Q0_v2:
    v_permlane32_swap_b32 v252, v254
    v_permlane32_swap_b32 v253, v255
    s_cmp_lg_u32 s3, 7
    s_cbranch_scc1 BOOT_d
    s_mov_b32 s19, 0
    s_cmp_lg_u32 s64, 0
    s_cbranch_scc1 BOOT_w1
    s_waitcnt vmcnt(3)
    s_branch BOOT_chk
BOOT_w1:
    s_waitcnt vmcnt(0)
BOOT_chk:
    v_and_b32 v5, 63, v135
    v_cmp_ne_u32 vcc, 32, v5
    s_nop 0
    s_cbranch_vccz BOOT_done
    s_add_u32 s19, s19, 1
    s_cmp_gt_u32 s19, 200000
    s_cbranch_scc1 BOOT_done
    buffer_load_dword v135, v2, s[44:47], 0 offen sc1
    s_waitcnt vmcnt(0)
    s_branch BOOT_chk
BOOT_done:
    s_lshr_b32 s18, s28, 5
    s_nop 3
    v_readlane_b32 s18, v135, s18
    s_lshl_b32 s19, s34, 5
    s_nop 1
    s_cmp_eq_u32 s18, s19
    s_cselect_b32 s65, 1, 0
BOOT_d:
    v_add_f32 v96, v96, v99
    s_waitcnt lgkmcnt(0)
    s_barrier
    s_cmp_lg_u32 s64, 0
    s_cbranch_scc1 Q0_nostg3
    s_add_u32 m0, s52, 122880
    s_mul_i32 s17, s48, 3
    buffer_load_dwordx4 v136, s[40:43], s17 offen lds
Q0_nostg3:
    s_cmp_lg_u32 s3, 7
    s_cbranch_scc1 Q0_nomode
    v_mov_b32 v10, s65
    v_mov_b32 v11, 163328
    ds_write_b32 v11, v10
Q0_nomode:
    v_and_b32 v3, 31, v0
    v_lshlrev_b32 v3, 2, v3
    s_lshl_b32 s17, s3, 9
    s_add_u32 s17, s17, 57344
    v_lshrrev_b32 v2, 1, v1
    v_add_u32 v2, s17, v2
    v_add_f32 v97, v97, v98
    ds_write_b64 v2, v[132:133]
    v_mov_b32 v8, v96
    v_mov_b32 v9, v97
    s_lshl_b32 s17, s3, 7
    s_add_u32 s17, s17, 161792
    v_add_u32 v5, s17, v3
    s_lshl_b32 s17, s15, 7
    s_add_u32 s17, s17, 162816
    v_add_u32 v3, s17, v3
    v_permlane32_swap_b32 v8, v96
    v_permlane32_swap_b32 v9, v97
    v_add_f32 v8, v8, v96
    v_add_f32 v9, v9, v97
    ds_write_b32 v5, v8
    s_cmp_lg_u32 s63, 0
    s_cbranch_scc1 Q0_nk
    ds_write_b32 v3, v9
QKV_kv:
    s_lshl_b32 s18, s15, 11
    s_add_u32 s17, s18, 40960
    v_add_u32 v2, s17, v1
    s_waitcnt vmcnt(7)
    v_mfma_f32_32x32x16_bf16 v[80:95], v[220:223], v[16:19], 0
    s_waitcnt vmcnt(6)
    v_mfma_f32_32x32x16_bf16 v[80:95], v[224:227], v[20:23], v[80:95]
    s_waitcnt vmcnt(5)
    v_mfma_f32_32x32x16_bf16 v[80:95], v[228:231], v[24:27], v[80:95]
    s_waitcnt vmcnt(4)
    v_mfma_f32_32x32x16_bf16 v[80:95], v[232:235], v[28:31], v[80:95]
    s_waitcnt vmcnt(3)
    v_mfma_f32_32x32x16_bf16 v[80:95], v[236:239], v[32:35], v[80:95]
    s_waitcnt vmcnt(2)
    v_mfma_f32_32x32x16_bf16 v[80:95], v[240:243], v[36:39], v[80:95]
    s_waitcnt vmcnt(1)
    v_mfma_f32_32x32x16_bf16 v[80:95], v[244:247], v[40:43], v[80:95]
    s_waitcnt vmcnt(0)
    v_mfma_f32_32x32x16_bf16 v[80:95], v[248:251], v[44:47], v[80:95]
    v_and_b32 v12, 31, v0
    v_lshlrev_b32 v12, 3, v12
    s_lshl_b32 s17, s14, 11
    s_add_u32 s17, s17, 57344
    v_add_u32 v12, s17, v12
    s_lshl_b32 s18, s15, 13
    s_add_u32 s17, s18, 40960
    v_add_u32 v10, s17, v1
    s_lshl_b32 s18, s15, 6
    s_add_u32 s18, s18, 162816
    v_add_u32 v11, s18, v4
    v_mov_b32 v8, 163328
    ds_write_b128 v2, v[80:83] offset:0
    ds_write_b128 v2, v[84:87] offset:1024
    ds_write_b128 v2, v[88:91] offset:8192
    ds_write_b128 v2, v[92:95] offset:9216
    s_waitcnt lgkmcnt(0)
    s_barrier
    s_cmp_ge_u32 s15, 2
    s_cbranch_scc1 QKV_kv2
    ds_read_b32 v9, v8
    ds_read_b64 v[136:137], v12 offset:0
    ds_read_b64 v[138:139], v12 offset:256
    ds_read_b64 v[140:141], v12 offset:512
    ds_read_b64 v[142:143], v12 offset:768
    ds_read_b64 v[144:145], v12 offset:1024
    ds_read_b64 v[146:147], v12 offset:1280
    ds_read_b64 v[148:149], v12 offset:1536
    ds_read_b64 v[150:151], v12 offset:1792
    ds_read_b128 v[96:99], v10 offset:0
    ds_read_b128 v[100:103], v10 offset:1024
    ds_read_b128 v[104:107], v10 offset:2048
    ds_read_b128 v[108:111], v10 offset:3072
    ds_read_b128 v[112:115], v10 offset:4096
    ds_read_b128 v[116:119], v10 offset:5120
    ds_read_b128 v[120:123], v10 offset:6144
    ds_read_b128 v[124:127], v10 offset:7168
    ds_read_b128 v[48:51], v11 offset:0
    ds_read_b128 v[52:55], v11 offset:32
    ds_read_b128 v[56:59], v11 offset:128
    ds_read_b128 v[60:63], v11 offset:160
    ds_read_b128 v[64:67], v11 offset:256
    ds_read_b128 v[68:71], v11 offset:288
    ds_read_b128 v[72:75], v11 offset:384
    ds_read_b128 v[76:79], v11 offset:416
    v_bfe_u32 v10, v0, 4, 1
    v_lshlrev_b32 v10, 9, v10
    v_bfe_u32 v7, v0, 2, 1
    v_lshl_add_u32 v10, v7, 8, v10
    v_bfe_u32 v7, v0, 3, 1
    v_lshl_add_u32 v10, v7, 3, v10
    v_and_b32 v7, 3, v0
    v_lshl_add_u32 v10, v7, 1, v10
    v_bfe_u32 v7, v0, 5, 1
    v_lshl_add_u32 v10, v7, 6, v10
    v_add_u32 v10, 61440, v10
    v_add_u32 v11, 61440, v1
    s_lshl_b32 s17, s62, 10
    s_add_u32 s17, s17, s31
    s_waitcnt lgkmcnt(15)
    v_readfirstlane_b32 s29, v9
    v_add_f32 v136, v136, v144
    v_add_f32 v137, v137, v145
    v_add_f32 v138, v138, v146
    v_add_f32 v139, v139, v147
    v_add_f32 v140, v140, v148
    v_add_f32 v141, v141, v149
    v_add_f32 v142, v142, v150
    v_add_f32 v143, v143, v151
    v_add_f32 v136, v136, v140
    v_add_f32 v137, v137, v141
    v_add_f32 v138, v138, v142
    v_add_f32 v139, v139, v143
    v_add_f32 v136, v136, v138
    v_add_f32 v137, v137, v139
    v_mul_f32 v136, 0x3b000000, v136
    v_mul_f32 v137, 0x3b000000, v137
    v_fma_f32 v137, -v136, v136, v137
    v_max_f32 v137, 0, v137
    v_add_f32 v137, 0x3727c5ac, v137
    v_rsq_f32 v137, v137
    s_waitcnt lgkmcnt(8)
    v_add_f32 v96, v96, v112
    v_add_f32 v97, v97, v113
    v_add_f32 v98, v98, v114
    v_add_f32 v99, v99, v115
    v_add_f32 v100, v100, v116
    v_add_f32 v101, v101, v117
    v_add_f32 v102, v102, v118
    v_add_f32 v103, v103, v119
    v_add_f32 v104, v104, v120
    v_add_f32 v105, v105, v121
    v_add_f32 v106, v106, v122
    v_add_f32 v107, v107, v123
    v_add_f32 v108, v108, v124
    v_add_f32 v109, v109, v125
    v_add_f32 v110, v110, v126
    v_add_f32 v111, v111, v127
    v_add_f32 v96, v96, v104
    v_add_f32 v97, v97, v105
    v_add_f32 v98, v98, v106
    v_add_f32 v99, v99, v107
    v_add_f32 v100, v100, v108
    v_add_f32 v101, v101, v109
    v_add_f32 v102, v102, v110
    v_add_f32 v103, v103, v111
    s_waitcnt lgkmcnt(0)
    v_add_f32 v48, v48, v64
    v_add_f32 v49, v49, v65
    v_add_f32 v50, v50, v66
    v_add_f32 v51, v51, v67
    v_add_f32 v52, v52, v68
    v_add_f32 v53, v53, v69
    v_add_f32 v54, v54, v70
    v_add_f32 v55, v55, v71
    v_add_f32 v56, v56, v72
    v_add_f32 v57, v57, v73
    v_add_f32 v58, v58, v74
    v_add_f32 v59, v59, v75
    v_add_f32 v60, v60, v76
    v_add_f32 v61, v61, v77
    v_add_f32 v62, v62, v78
    v_add_f32 v63, v63, v79
    v_add_f32 v48, v48, v56
    v_add_f32 v49, v49, v57
    v_add_f32 v50, v50, v58
    v_add_f32 v51, v51, v59
    v_add_f32 v52, v52, v60
    v_add_f32 v53, v53, v61
    v_add_f32 v54, v54, v62
    v_add_f32 v55, v55, v63
    v_fma_f32 v96, -v136, v48, v96
    v_fma_f32 v97, -v136, v49, v97
    v_fma_f32 v98, -v136, v50, v98
    v_fma_f32 v99, -v136, v51, v99
    v_fma_f32 v100, -v136, v52, v100
    v_fma_f32 v101, -v136, v53, v101
    v_fma_f32 v102, -v136, v54, v102
    v_fma_f32 v103, -v136, v55, v103
    v_mul_f32 v96, v137, v96
    v_mul_f32 v97, v137, v97
    v_mul_f32 v98, v137, v98
    v_mul_f32 v99, v137, v99
    v_mul_f32 v100, v137, v100
    v_mul_f32 v101, v137, v101
    v_mul_f32 v102, v137, v102
    v_mul_f32 v103, v137, v103
    v_cvt_pk_bf16_f32 v80, v96, v97
    v_cvt_pk_bf16_f32 v81, v98, v99
    v_cvt_pk_bf16_f32 v82, v100, v101
    v_cvt_pk_bf16_f32 v83, v102, v103
    s_add_u32 s17, s17, 2097152
    s_cmp_eq_u32 s15, 0
    s_cbranch_scc1 QKV_k
    ds_write_b16 v10, v80 offset:0
    ds_write_b16_d16_hi v10, v80 offset:16
    ds_write_b16 v10, v81 offset:32
    ds_write_b16_d16_hi v10, v81 offset:48
    ds_write_b16 v10, v82 offset:128
    ds_write_b16_d16_hi v10, v82 offset:144
    ds_write_b16 v10, v83 offset:160
    ds_write_b16_d16_hi v10, v83 offset:176
    ds_read_b128 v[80:83], v11
    s_add_u32 s17, s17, 65536
    s_waitcnt lgkmcnt(0)
QKV_k:
    buffer_store_dwordx4 v[80:83], v1, s[8:11], s17 offen sc1
    s_add_u32 s16, s32, 1
    v_mov_b32 v2, s16
    v_mov_b32 v3, 0
    s_lshl_b32 s22, s14, 3
    s_lshl_b32 s17, s15, 2
    s_add_u32 s22, s22, s17
    s_lshr_b32 s17, s28, 3
    s_lshl_b32 s18, s17, 8
    s_add_u32 s18, s18, s60
    s_add_u32 s18, s18, s22
    s_add_u32 s17, s56, s22
QKV_kv2:
    s_setprio 0
    s_cmp_eq_u32 s33, 0
    s_cbranch_scc1 QKV_kv3
    buffer_load_dwordx4 v[188:191], v1, s[8:11], s21 offen offset:0
    buffer_load_dwordx4 v[192:195], v1, s[8:11], s21 offen offset:1024
    buffer_load_dwordx4 v[196:199], v1, s[8:11], s21 offen offset:2048
    buffer_load_dwordx4 v[200:203], v1, s[8:11], s21 offen offset:3072
    s_add_u32 s19, s21, 4096
    buffer_load_dwordx4 v[204:207], v1, s[8:11], s19 offen offset:0
    buffer_load_dwordx4 v[208:211], v1, s[8:11], s19 offen offset:1024
    buffer_load_dwordx4 v[212:215], v1, s[8:11], s19 offen offset:2048
    buffer_load_dwordx4 v[216:219], v1, s[8:11], s19 offen offset:3072
    s_cmp_ge_u32 s15, 2
    s_cbranch_scc1 QKV_kv4
    s_mov_b64 exec, 1
    s_waitcnt vmcnt(8)
    s_cmp_eq_u32 s29, 0
    s_cbranch_scc1 ST_slow_1
    buffer_store_dword v2, v3, s[8:11], s17 offen
ST_done_2:
    buffer_store_dword v2, v3, s[8:11], s18 offen sc1
    s_mov_b64 exec, -1
    s_waitcnt vmcnt(2)
    s_branch QKV_kv3
QKV_kv4:
    s_waitcnt vmcnt(0)
QKV_kv3:
    v_mfma_f32_32x32x16_bf16 v[48:63], v[156:159], v[16:19], 0
    v_mfma_f32_32x32x16_bf16 v[64:79], v[188:191], v[16:19], 0
    v_mfma_f32_32x32x16_bf16 v[48:63], v[160:163], v[20:23], v[48:63]
    v_mfma_f32_32x32x16_bf16 v[64:79], v[192:195], v[20:23], v[64:79]
    v_mfma_f32_32x32x16_bf16 v[48:63], v[164:167], v[24:27], v[48:63]
    v_mfma_f32_32x32x16_bf16 v[64:79], v[196:199], v[24:27], v[64:79]
    v_mfma_f32_32x32x16_bf16 v[48:63], v[168:171], v[28:31], v[48:63]
    v_mfma_f32_32x32x16_bf16 v[64:79], v[200:203], v[28:31], v[64:79]
    v_mfma_f32_32x32x16_bf16 v[48:63], v[172:175], v[32:35], v[48:63]
    v_mfma_f32_32x32x16_bf16 v[64:79], v[204:207], v[32:35], v[64:79]
    v_mfma_f32_32x32x16_bf16 v[48:63], v[176:179], v[36:39], v[48:63]
    v_mfma_f32_32x32x16_bf16 v[64:79], v[208:211], v[36:39], v[64:79]
    v_mfma_f32_32x32x16_bf16 v[48:63], v[180:183], v[40:43], v[48:63]
    v_mfma_f32_32x32x16_bf16 v[64:79], v[212:215], v[40:43], v[64:79]
    v_mfma_f32_32x32x16_bf16 v[48:63], v[184:187], v[44:47], v[48:63]
    v_mfma_f32_32x32x16_bf16 v[64:79], v[216:219], v[44:47], v[64:79]
    s_lshl_b32 s16, s33, 2
    s_add_u32 s16, s16, s15
    s_cmp_ge_u32 s16, 2
    s_cbranch_scc1 QKV_mmw
    s_mov_b64 exec, 1
    s_waitcnt vmcnt(0)
    s_cmp_eq_u32 s29, 0
    s_cbranch_scc1 ST_slow_3
    buffer_store_dword v2, v3, s[8:11], s17 offen
ST_done_4:
    buffer_store_dword v2, v3, s[8:11], s18 offen sc1
    s_mov_b64 exec, -1
    s_branch QKV_mmdone
Q0_nk:
    v_mfma_f32_32x32x16_bf16 v[48:63], v[156:159], v[16:19], 0
    v_mfma_f32_32x32x16_bf16 v[48:63], v[160:163], v[20:23], v[48:63]
    v_mfma_f32_32x32x16_bf16 v[48:63], v[164:167], v[24:27], v[48:63]
    v_mfma_f32_32x32x16_bf16 v[48:63], v[168:171], v[28:31], v[48:63]
    v_mfma_f32_32x32x16_bf16 v[48:63], v[172:175], v[32:35], v[48:63]
    v_mfma_f32_32x32x16_bf16 v[48:63], v[176:179], v[36:39], v[48:63]
    v_mfma_f32_32x32x16_bf16 v[48:63], v[180:183], v[40:43], v[48:63]
    v_mfma_f32_32x32x16_bf16 v[48:63], v[184:187], v[44:47], v[48:63]
    s_cmp_eq_u32 s64, 0
    s_cbranch_scc1 NKB_5
    s_waitcnt lgkmcnt(0)
    s_barrier
NKB_5:
    v_mfma_f32_32x32x16_bf16 v[64:79], v[188:191], v[16:19], 0
    v_mfma_f32_32x32x16_bf16 v[64:79], v[192:195], v[20:23], v[64:79]
    v_mfma_f32_32x32x16_bf16 v[64:79], v[196:199], v[24:27], v[64:79]
    v_mfma_f32_32x32x16_bf16 v[64:79], v[200:203], v[28:31], v[64:79]
    v_mfma_f32_32x32x16_bf16 v[64:79], v[204:207], v[32:35], v[64:79]
    v_mfma_f32_32x32x16_bf16 v[64:79], v[208:211], v[36:39], v[64:79]
    v_mfma_f32_32x32x16_bf16 v[64:79], v[212:215], v[40:43], v[64:79]
    v_mfma_f32_32x32x16_bf16 v[64:79], v[216:219], v[44:47], v[64:79]
QKV_mmw:
    s_nop 2
QKV_mmdone:
    s_lshl_b32 s17, s14, 16
    s_lshl_b32 s18, s15, 11
    s_add_u32 s17, s17, s18
    s_add_u32 s17, s17, 8192
    s_lshl_b32 s18, s14, 14
    s_add_u32 s16, s18, s17
    v_add_u32 v2, s16, v1
    s_xor_b32 s18, s18, 0x4000
    s_add_u32 s16, s18, s17
    v_add_u32 v3, s16, v1
    ds_write_b128 v2, v[48:51] offset:0
    ds_write_b128 v2, v[52:55] offset:1024
    ds_write_b128 v2, v[56:59] offset:8192
    ds_write_b128 v2, v[60:63] offset:9216
    ds_write_b128 v3, v[64:67] offset:0
    ds_write_b128 v3, v[68:71] offset:1024
    ds_write_b128 v3, v[72:75] offset:8192
    ds_write_b128 v3, v[76:79] offset:9216
    s_add_u32 s32, s32, 1
    s_cmp_lg_u32 s3, 7
    s_cbranch_scc1 QKV_np
    s_and_b32 s18, s56, 0xffffff80
    v_and_b32 v2, 15, v0
    v_lshlrev_b32 v2, 2, v2
    s_mov_b32 s19, 0
POLL_6:
    buffer_load_dword v3, v2, s[8:11], s18 offen sc1
    s_add_u32 s19, s19, 1
    s_waitcnt vmcnt(0)
    v_cmp_gt_u32 vcc, s32, v3
    s_cmp_gt_u32 s19, 200000
    s_cbranch_scc1 POLLE_7
    s_cbranch_vccnz POLL_6
POLLE_7:
QKV_np:
    v_and_b32 v2, 31, v0
    v_lshlrev_b32 v2, 3, v2
    s_lshl_b32 s17, s14, 11
    s_add_u32 s17, s17, 57344
    v_add_u32 v2, s17, v2
    v_mov_b32 v8, 163328
    s_lshl_b32 s20, s14, 16
    s_lshl_b32 s17, s15, 13
    s_add_u32 s20, s20, s17
    s_add_u32 s20, s20, 8192
    v_add_u32 v3, s20, v1
    s_lshr_b32 s17, s15, 1
    s_lshl_b32 s17, s17, 9
    s_and_b32 s18, s15, 1
    s_lshl_b32 s18, s18, 6
    s_add_u32 s17, s17, s18
    s_add_u32 s17, s17, 161792
    v_add_u32 v5, s17, v4
    s_add_u32 s16, s53, s59
    s_add_u32 s17, s16, 65536
    s_mov_b32 m0, s52
    s_waitcnt lgkmcnt(0)
    s_barrier
    buffer_load_dwordx4 v1, s[8:11], s16 offen sc1 lds
    s_add_u32 m0, s52, 65536
    s_nop 0
    buffer_load_dwordx4 v1, s[8:11], s17 offen sc1 lds
    ds_read_b32 v9, v8
    ds_read_b64 v[16:17], v2 offset:0
    ds_read_b64 v[18:19], v2 offset:256
    ds_read_b64 v[20:21], v2 offset:512
    ds_read_b64 v[22:23], v2 offset:768
    ds_read_b64 v[24:25], v2 offset:1024
    ds_read_b64 v[26:27], v2 offset:1280
    ds_read_b64 v[28:29], v2 offset:1536
    ds_read_b64 v[30:31], v2 offset:1792
    ds_read_b128 v[32:35], v3 offset:0
    ds_read_b128 v[36:39], v3 offset:1024
    ds_read_b128 v[40:43], v3 offset:2048
    ds_read_b128 v[44:47], v3 offset:3072
    ds_read_b128 v[48:51], v3 offset:4096
    ds_read_b128 v[52:55], v3 offset:5120
    ds_read_b128 v[56:59], v3 offset:6144
    ds_read_b128 v[60:63], v3 offset:7168
    ds_read_b128 v[64:67], v5 offset:0
    ds_read_b128 v[68:71], v5 offset:32
    ds_read_b128 v[72:75], v5 offset:128
    ds_read_b128 v[76:79], v5 offset:160
    ds_read_b128 v[80:83], v5 offset:256
    ds_read_b128 v[84:87], v5 offset:288
    ds_read_b128 v[88:91], v5 offset:384
    ds_read_b128 v[92:95], v5 offset:416
    s_waitcnt lgkmcnt(15)
    v_readfirstlane_b32 s29, v9
    v_pk_add_f32 v[16:17], v[16:17], v[24:25]
    v_pk_add_f32 v[18:19], v[18:19], v[26:27]
    v_pk_add_f32 v[20:21], v[20:21], v[28:29]
    v_pk_add_f32 v[22:23], v[22:23], v[30:31]
    v_pk_add_f32 v[16:17], v[16:17], v[20:21]
    v_pk_add_f32 v[18:19], v[18:19], v[22:23]
    v_pk_add_f32 v[16:17], v[16:17], v[18:19]
    v_mul_f32 v16, 0x3b000000, v16
    v_mul_f32 v17, 0x3b000000, v17
    v_fma_f32 v17, -v16, v16, v17
    v_max_f32 v17, 0, v17
    v_add_f32 v17, 0x3727c5ac, v17
    v_rsq_f32 v18, v17
    v_mov_b32 v17, v16
    v_mul_f32 v20, 0x3eb8aa3b, v18
    v_mul_f32 v21, 0x3eb8aa3b, v18
    s_waitcnt lgkmcnt(8)
    v_pk_add_f32 v[32:33], v[32:33], v[40:41]
    v_pk_add_f32 v[48:49], v[48:49], v[56:57]
    v_pk_add_f32 v[34:35], v[34:35], v[42:43]
    v_pk_add_f32 v[50:51], v[50:51], v[58:59]
    v_pk_add_f32 v[36:37], v[36:37], v[44:45]
    v_pk_add_f32 v[52:53], v[52:53], v[60:61]
    v_pk_add_f32 v[38:39], v[38:39], v[46:47]
    v_pk_add_f32 v[54:55], v[54:55], v[62:63]
    v_pk_add_f32 v[32:33], v[32:33], v[48:49]
    v_pk_add_f32 v[34:35], v[34:35], v[50:51]
    v_pk_add_f32 v[36:37], v[36:37], v[52:53]
    v_pk_add_f32 v[38:39], v[38:39], v[54:55]
    s_waitcnt lgkmcnt(0)
    v_pk_add_f32 v[64:65], v[64:65], v[72:73]
    v_pk_add_f32 v[80:81], v[80:81], v[88:89]
    v_pk_add_f32 v[66:67], v[66:67], v[74:75]
    v_pk_add_f32 v[82:83], v[82:83], v[90:91]
    v_pk_add_f32 v[68:69], v[68:69], v[76:77]
    v_pk_add_f32 v[84:85], v[84:85], v[92:93]
    v_pk_add_f32 v[70:71], v[70:71], v[78:79]
    v_pk_add_f32 v[86:87], v[86:87], v[94:95]
    v_pk_add_f32 v[64:65], v[64:65], v[80:81]
    v_pk_add_f32 v[66:67], v[66:67], v[82:83]
    v_pk_add_f32 v[68:69], v[68:69], v[84:85]
    v_pk_add_f32 v[70:71], v[70:71], v[86:87]
    v_pk_fma_f32 v[32:33], v[64:65], v[16:17], v[32:33] neg_lo:[0,1,0] neg_hi:[0,1,0]
    v_pk_fma_f32 v[34:35], v[66:67], v[16:17], v[34:35] neg_lo:[0,1,0] neg_hi:[0,1,0]
    v_pk_fma_f32 v[36:37], v[68:69], v[16:17], v[36:37] neg_lo:[0,1,0] neg_hi:[0,1,0]
    v_pk_fma_f32 v[38:39], v[70:71], v[16:17], v[38:39] neg_lo:[0,1,0] neg_hi:[0,1,0]
    v_pk_mul_f32 v[32:33], v[32:33], v[20:21]
    v_pk_mul_f32 v[34:35], v[34:35], v[20:21]
    v_pk_mul_f32 v[36:37], v[36:37], v[20:21]
    v_pk_mul_f32 v[38:39], v[38:39], v[20:21]
    v_cvt_pk_bf16_f32 v4, v32, v33
    v_cvt_pk_bf16_f32 v5, v34, v35
    v_cvt_pk_bf16_f32 v6, v36, v37
    v_cvt_pk_bf16_f32 v7, v38, v39
    s_or_b32 s57, s33, s64
    s_cbranch_scc1 ATT_np
    v_bfe_u32 v148, v0, 2, 2
    v_and_b32 v149, 3, v0
    v_lshlrev_b32 v149, 3, v149
    v_bfe_u32 v152, v0, 4, 1
    v_bfe_u32 v153, v0, 5, 1
    v_lshl_add_u32 v154, v153, 2, v148
    v_lshl_add_u32 v154, v154, 7, v149
    s_lshr_b32 s12, s3, 2
    s_and_b32 s13, s3, 3
    s_cmp_lt_u32 s50, 112
    s_cbranch_scc0 PS_c
    v_lshl_add_u32 v140, v152, 2, v148
    v_lshl_add_u32 v140, v153, 4, v140
    v_lshl_add_u32 v140, v140, 7, v149
    s_lshl_b32 s16, s12, 12
    s_lshl_b32 s18, s13, 5
    s_add_u32 s16, s16, s18
    s_and_b32 s17, s50, 0xfc
    s_add_u32 s17, s17, s13
    s_lshl_b32 s17, s17, 5
    s_and_b32 s18, s50, 3
    s_lshl_b32 s18, s18, 3
    s_add_u32 s17, s17, s18
    s_add_u32 s17, s17, s12
    s_lshl_b32 s17, s17, 10
    s_add_u32 s17, s17, 2097152
    s_movk_i32 s49, 2048
    s_branch PS_e
PS_c:
    v_lshl_add_u32 v140, v152, 5, v154
    s_lshr_b32 s12, s3, 1
    s_lshl_b32 s16, s12, 11
    s_and_b32 s19, s3, 1
    s_lshl_b32 s13, s19, 6
    s_add_u32 s16, s16, s13
    s_lshr_b32 s18, s51, 3
    s_and_b32 s17, s51, 7
    s_cmp_lt_u32 s50, 168
    s_cbranch_scc0 PS_d
    s_movk_i32 s49, 8192
    s_lshl_b32 s18, s18, 15
    s_add_u32 s18, s18, s52
    s_mul_i32 s17, s17, 229376
    s_add_u32 s17, s17, s18
    s_add_u32 s17, s17, 6291456
    s_branch PS_e
PS_d:
    s_movk_i32 s49, 4096
    s_lshl_b32 s17, s17, 1
    s_add_u32 s17, s17, s19
    s_lshl_b32 s17, s17, 5
    s_lshl_b32 s18, s18, 4
    s_add_u32 s17, s17, s18
    s_add_u32 s17, s17, s12
    s_lshl_b32 s17, s17, 10
    s_add_u32 s17, s17, 524288
    s_cmp_lt_u32 s50, 184
    s_cselect_b32 s17, s17, 1879048192
PS_e:
    v_add_u32 v140, s16, v140
    v_add_u32 v141, 135168, v140
    v_add_u32 v140, 122880, v140
    v_add_u32 v144, s17, v1
ATT_np:
    s_mov_b32 s23, s59
    v_lshlrev_b32 v10, 3, v0
    v_add_u32 v10, 131072, v10
    v_and_b32 v11, 2, v0
    v_cmp_eq_u32 vcc, 0, v11
    s_nop 1
    v_cndmask_b32 v14, 0, v128, vcc
    v_cndmask_b32 v15, 0, v128, vcc
    ds_write_b64 v10, v[14:15]
    v_and_b32 v10, 15, v0
    v_lshlrev_b32 v9, 7, v10
    v_lshlrev_b32 v10, 4, v10
    v_bfe_u32 v11, v0, 5, 1
    v_lshl_add_u32 v10, v11, 8, v10
    v_add_u32 v14, 65536, v10
    v_and_b32 v120, 31, v0
    v_lshlrev_b32 v120, 8, v120
    v_lshl_add_u32 v121, v11, 4, v120
    v_and_b32 v11, 11, v0
    v_min_u32 v11, 1, v11
    v_lshlrev_b32 v11, 4, v11
    v_and_b32 v15, 16, v0
    v_cmp_eq_u32 vcc, 0, v15
    v_add_u32 v13, 4, v0
    v_and_b32 v13, 8, v13
    v_lshl_add_u32 v11, v13, 3, v11
    v_add_u32 v11, 131072, v11
    v_cndmask_b32 v3, v11, v14, vcc
    v_mov_b32 v11, 4096
    v_cndmask_b32 v12, 0, v11, vcc
    v_mov_b32 v2, v1
    v_lshrrev_b32 v11, 2, v1
    s_add_u32 s21, s61, s35
    s_waitcnt vmcnt(0)
    s_cmp_lg_u32 s3, 7
    s_cbranch_scc1 ATT_k_l
    buffer_load_dwordx4 v[116:119], v120, s[8:11], s60 offen offset:0 sc1
ATT_k_l:
    s_waitcnt lgkmcnt(0)
    s_barrier
    ds_read_b128 v[80:83], v2
    ds_read_b128 v[84:87], v3
    s_waitcnt lgkmcnt(1)
    v_mfma_f32_32x32x16_bf16 v[32:47], v[80:83], v[4:7], 0
    ds_read_b128 v[80:83], v2 offset:1024
    s_nop 10
    v_max3_f32 v14, v32, v33, v34
    v_max3_f32 v14, v14, v35, v36
    v_max3_f32 v14, v14, v37, v38
    v_max3_f32 v14, v14, v39, v40
    v_max3_f32 v14, v14, v41, v42
    v_max3_f32 v14, v14, v43, v44
    v_max3_f32 v14, v14, v45, v46
    v_max_f32 v14, v14, v47
    v_mov_b32 v15, v14
    s_nop 1
    v_permlane32_swap_b32 v14, v15
    v_max_f32 v14, v14, v15
    v_sub_f32 v16, 0, v14
    v_sub_f32 v17, 0, v14
    v_pk_add_f32 v[32:33], v[32:33], v[16:17]
    v_pk_add_f32 v[34:35], v[34:35], v[16:17]
    v_pk_add_f32 v[36:37], v[36:37], v[16:17]
    v_pk_add_f32 v[38:39], v[38:39], v[16:17]
    v_pk_add_f32 v[40:41], v[40:41], v[16:17]
    v_pk_add_f32 v[42:43], v[42:43], v[16:17]
    v_pk_add_f32 v[44:45], v[44:45], v[16:17]
    v_pk_add_f32 v[46:47], v[46:47], v[16:17]
    v_mov_b32 v18, v16
    v_mov_b32 v19, v16
    v_mov_b32 v20, v16
    v_mov_b32 v21, v16
    v_mov_b32 v22, v16
    v_mov_b32 v23, v16
    v_mov_b32 v24, v16
    v_mov_b32 v25, v16
    v_mov_b32 v26, v16
    v_mov_b32 v27, v16
    v_mov_b32 v28, v16
    v_mov_b32 v29, v16
    v_mov_b32 v30, v16
    v_mov_b32 v31, v16
    s_waitcnt lgkmcnt(0)
    s_setprio 0
    v_exp_f32 v32, v32
    v_exp_f32 v33, v33
    v_exp_f32 v34, v34
    ds_read_b128 v[88:91], v3 offset:512
    s_cmp_lg_u32 s57, 0
    s_cbranch_scc1 ATT_p1
    ds_read_b64_tr_b16 v[92:93], v141 offset:0
    ds_read_b64_tr_b16 v[94:95], v141 offset:1024
    ds_read_b64_tr_b16 v[96:97], v141 offset:8192
    ds_read_b64_tr_b16 v[98:99], v141 offset:9216
    ds_read_b64_tr_b16 v[100:101], v141 offset:16384
    ds_read_b64_tr_b16 v[102:103], v141 offset:17408
    ds_read_b64_tr_b16 v[104:105], v140 offset:0
    ds_read_b64_tr_b16 v[106:107], v140 offset:1024
ATT_p1:
    v_cvt_pk_bf16_f32 v32, v32, v33
    v_exp_f32 v35, v35
    v_exp_f32 v36, v36
    v_exp_f32 v37, v37
    v_cvt_pk_bf16_f32 v33, v34, v35
    v_exp_f32 v38, v38
    v_exp_f32 v39, v39
    v_mfma_f32_32x32x16_bf16 v[48:63], v[80:83], v[4:7], v[16:31]
    ds_read_b128 v[80:83], v2 offset:2048
    s_waitcnt lgkmcnt(2)
    v_cvt_pk_bf16_f32 v34, v36, v37
    v_exp_f32 v40, v40
    v_exp_f32 v41, v41
    v_cvt_pk_bf16_f32 v35, v38, v39
    v_exp_f32 v42, v42
    v_exp_f32 v43, v43
    v_cvt_pk_bf16_f32 v40, v40, v41
    v_exp_f32 v44, v44
    v_mfma_f32_32x32x16_bf16 v[64:79], v[84:87], v[32:35], 0
    ds_read_b128 v[84:87], v3 offset:1024
    s_waitcnt lgkmcnt(1)
    v_exp_f32 v45, v45
    v_cvt_pk_bf16_f32 v41, v42, v43
    v_exp_f32 v46, v46
    v_exp_f32 v47, v47
    v_cvt_pk_bf16_f32 v42, v44, v45
    v_cvt_pk_bf16_f32 v43, v46, v47
    s_cmp_lg_u32 s3, 7
    s_cbranch_scc1 ATT_k_ok
    s_waitcnt vmcnt(0)
    v_min_u32 v116, v116, v117
    v_min3_u32 v116, v116, v118, v119
    v_cmp_gt_u32 vcc, s32, v116
    s_nop 0
    s_cbranch_vccnz ATT_k_s
ATT_k_ok:
    s_barrier
    s_setprio 3
    v_exp_f32 v48, v48
    v_exp_f32 v49, v49
    v_exp_f32 v50, v50
    v_mfma_f32_32x32x16_bf16 v[64:79], v[88:91], v[40:43], v[64:79]
    ds_read_b128 v[88:91], v3 offset:1536
    s_add_u32 s23, s23, 8192
    s_and_b32 s23, s23, 0xffff
    s_add_u32 s15, s53, s23
    s_add_u32 m0, s52, 8192
    s_nop 0
    buffer_load_dwordx4 v1, s[8:11], s15 offen sc1 lds
    v_cvt_pk_bf16_f32 v48, v48, v49
    v_exp_f32 v51, v51
    v_exp_f32 v52, v52
    v_exp_f32 v53, v53
    v_cvt_pk_bf16_f32 v49, v50, v51
    v_exp_f32 v54, v54
    v_exp_f32 v55, v55
    v_mfma_f32_32x32x16_bf16 v[32:47], v[80:83], v[4:7], v[16:31]
    ds_read_b128 v[80:83], v2 offset:3072
    s_waitcnt lgkmcnt(2)
    v_cvt_pk_bf16_f32 v50, v52, v53
    v_exp_f32 v56, v56
    v_exp_f32 v57, v57
    v_cvt_pk_bf16_f32 v51, v54, v55
    v_exp_f32 v58, v58
    v_exp_f32 v59, v59
    v_cvt_pk_bf16_f32 v56, v56, v57
    v_exp_f32 v60, v60
    v_mfma_f32_32x32x16_bf16 v[64:79], v[84:87], v[48:51], v[64:79]
    ds_read_b128 v[84:87], v3 offset:2048
    s_waitcnt lgkmcnt(1)
    s_add_u32 s15, s15, 65536
    s_add_u32 m0, s52, 73728
    s_nop 0
    buffer_load_dwordx4 v1, s[8:11], s15 offen sc1 lds
    v_exp_f32 v61, v61
    v_cvt_pk_bf16_f32 v57, v58, v59
    v_exp_f32 v62, v62
    v_exp_f32 v63, v63
    v_cvt_pk_bf16_f32 v58, v60, v61
    v_cvt_pk_bf16_f32 v59, v62, v63
    v_exp_f32 v32, v32
    v_exp_f32 v33, v33
    v_exp_f32 v34, v34
    v_mfma_f32_32x32x16_bf16 v[64:79], v[88:91], v[56:59], v[64:79]
    ds_read_b128 v[88:91], v3 offset:2560
    s_add_u32 s23, s23, 8192
    s_and_b32 s23, s23, 0xffff
    s_add_u32 s15, s53, s23
    s_add_u32 m0, s52, 16384
    s_nop 0
    buffer_load_dwordx4 v1, s[8:11], s15 offen sc1 lds
    v_cvt_pk_bf16_f32 v32, v32, v33
    v_exp_f32 v35, v35
    v_exp_f32 v36, v36
    v_exp_f32 v37, v37
    v_cvt_pk_bf16_f32 v33, v34, v35
    v_exp_f32 v38, v38
    v_exp_f32 v39, v39
    v_mfma_f32_32x32x16_bf16 v[48:63], v[80:83], v[4:7], v[16:31]
    ds_read_b128 v[80:83], v2 offset:4096
    s_waitcnt lgkmcnt(2)
    v_cvt_pk_bf16_f32 v34, v36, v37
    v_exp_f32 v40, v40
    v_exp_f32 v41, v41
    v_cvt_pk_bf16_f32 v35, v38, v39
    v_exp_f32 v42, v42
    v_exp_f32 v43, v43
    v_cvt_pk_bf16_f32 v40, v40, v41
    v_exp_f32 v44, v44
    v_mfma_f32_32x32x16_bf16 v[64:79], v[84:87], v[32:35], v[64:79]
    ds_read_b128 v[84:87], v3 offset:3072
    s_waitcnt lgkmcnt(1)
    s_add_u32 s15, s15, 65536
    s_add_u32 m0, s52, 81920
    s_nop 0
    buffer_load_dwordx4 v1, s[8:11], s15 offen sc1 lds
    v_exp_f32 v45, v45
    v_cvt_pk_bf16_f32 v41, v42, v43
    v_exp_f32 v46, v46
    v_exp_f32 v47, v47
    v_cvt_pk_bf16_f32 v42, v44, v45
    v_cvt_pk_bf16_f32 v43, v46, v47
    v_exp_f32 v48, v48
    v_exp_f32 v49, v49
    v_exp_f32 v50, v50
    v_mfma_f32_32x32x16_bf16 v[64:79], v[88:91], v[40:43], v[64:79]
    ds_read_b128 v[88:91], v3 offset:3584
    s_add_u32 s23, s23, 8192
    s_and_b32 s23, s23, 0xffff
    s_add_u32 s15, s53, s23
    s_add_u32 m0, s52, 24576
    s_nop 0
    buffer_load_dwordx4 v1, s[8:11], s15 offen sc1 lds
    v_cvt_pk_bf16_f32 v48, v48, v49
    v_exp_f32 v51, v51
    v_exp_f32 v52, v52
    v_exp_f32 v53, v53
    v_cvt_pk_bf16_f32 v49, v50, v51
    v_exp_f32 v54, v54
    v_exp_f32 v55, v55
    v_mfma_f32_32x32x16_bf16 v[32:47], v[80:83], v[4:7], v[16:31]
    ds_read_b128 v[80:83], v2 offset:5120
    s_waitcnt lgkmcnt(2)
    v_cvt_pk_bf16_f32 v50, v52, v53
    v_exp_f32 v56, v56
    v_exp_f32 v57, v57
    v_cvt_pk_bf16_f32 v51, v54, v55
    v_exp_f32 v58, v58
    v_exp_f32 v59, v59
    v_cvt_pk_bf16_f32 v56, v56, v57
    v_add_u32 v3, v3, v12
    v_exp_f32 v60, v60
    v_mfma_f32_32x32x16_bf16 v[64:79], v[84:87], v[48:51], v[64:79]
    ds_read_b128 v[84:87], v3 offset:0
    s_waitcnt lgkmcnt(1)
    s_add_u32 s15, s15, 65536
    s_add_u32 m0, s52, 90112
    s_nop 0
    buffer_load_dwordx4 v1, s[8:11], s15 offen sc1 lds
    v_exp_f32 v61, v61
    v_cvt_pk_bf16_f32 v57, v58, v59
    v_exp_f32 v62, v62
    v_add_u32 v2, 4096, v2
    v_exp_f32 v63, v63
    v_cvt_pk_bf16_f32 v58, v60, v61
    v_cvt_pk_bf16_f32 v59, v62, v63
    s_setprio 2
    v_exp_f32 v32, v32
    v_exp_f32 v33, v33
    v_exp_f32 v34, v34
    v_mfma_f32_32x32x16_bf16 v[64:79], v[88:91], v[56:59], v[64:79]
    ds_read_b128 v[88:91], v3 offset:512
    s_add_u32 s23, s23, 8192
    s_and_b32 s23, s23, 0xffff
    s_add_u32 s15, s53, s23
    s_add_u32 m0, s52, 32768
    s_nop 0
    buffer_load_dwordx4 v1, s[8:11], s15 offen sc1 lds
    v_cvt_pk_bf16_f32 v32, v32, v33
    v_exp_f32 v35, v35
    v_exp_f32 v36, v36
    v_exp_f32 v37, v37
    v_cvt_pk_bf16_f32 v33, v34, v35
    v_exp_f32 v38, v38
    v_exp_f32 v39, v39
    v_mfma_f32_32x32x16_bf16 v[48:63], v[80:83], v[4:7], v[16:31]
    ds_read_b128 v[80:83], v2 offset:2048
    s_waitcnt lgkmcnt(2)
    v_cvt_pk_bf16_f32 v34, v36, v37
    v_exp_f32 v40, v40
    v_exp_f32 v41, v41
    v_cvt_pk_bf16_f32 v35, v38, v39
    v_exp_f32 v42, v42
    v_exp_f32 v43, v43
    v_cvt_pk_bf16_f32 v40, v40, v41
    v_exp_f32 v44, v44
    v_mfma_f32_32x32x16_bf16 v[64:79], v[84:87], v[32:35], v[64:79]
    ds_read_b128 v[84:87], v3 offset:1024
    s_waitcnt lgkmcnt(1)
    s_add_u32 s15, s15, 65536
    s_add_u32 m0, s52, 98304
    s_nop 0
    buffer_load_dwordx4 v1, s[8:11], s15 offen sc1 lds
    v_exp_f32 v45, v45
    v_cvt_pk_bf16_f32 v41, v42, v43
    v_exp_f32 v46, v46
    v_exp_f32 v47, v47
    v_cvt_pk_bf16_f32 v42, v44, v45
    v_cvt_pk_bf16_f32 v43, v46, v47
    s_setprio 0
    v_exp_f32 v48, v48
    v_exp_f32 v49, v49
    v_exp_f32 v50, v50
    v_mfma_f32_32x32x16_bf16 v[64:79], v[88:91], v[40:43], v[64:79]
    ds_read_b128 v[88:91], v3 offset:1536
    s_add_u32 s23, s23, 8192
    s_and_b32 s23, s23, 0xffff
    s_add_u32 s15, s53, s23
    s_add_u32 m0, s52, 40960
    s_nop 0
    buffer_load_dwordx4 v1, s[8:11], s15 offen sc1 lds
    v_cvt_pk_bf16_f32 v48, v48, v49
    v_exp_f32 v51, v51
    v_exp_f32 v52, v52
    v_exp_f32 v53, v53
    v_cvt_pk_bf16_f32 v49, v50, v51
    v_exp_f32 v54, v54
    v_exp_f32 v55, v55
    v_mfma_f32_32x32x16_bf16 v[32:47], v[80:83], v[4:7], v[16:31]
    ds_read_b128 v[80:83], v2 offset:3072
    s_waitcnt lgkmcnt(2)
    v_cvt_pk_bf16_f32 v50, v52, v53
    v_exp_f32 v56, v56
    v_exp_f32 v57, v57
    v_cvt_pk_bf16_f32 v51, v54, v55
    v_exp_f32 v58, v58
    v_exp_f32 v59, v59
    v_cvt_pk_bf16_f32 v56, v56, v57
    v_exp_f32 v60, v60
    v_mfma_f32_32x32x16_bf16 v[64:79], v[84:87], v[48:51], v[64:79]
    ds_read_b128 v[84:87], v3 offset:2048
    s_waitcnt lgkmcnt(1)
    s_add_u32 s15, s15, 65536
    s_add_u32 m0, s52, 106496
    s_nop 0
    buffer_load_dwordx4 v1, s[8:11], s15 offen sc1 lds
    v_exp_f32 v61, v61
    v_cvt_pk_bf16_f32 v57, v58, v59
    v_exp_f32 v62, v62
    v_exp_f32 v63, v63
    v_cvt_pk_bf16_f32 v58, v60, v61
    v_cvt_pk_bf16_f32 v59, v62, v63
    s_waitcnt vmcnt(4)
    s_barrier
    s_setprio 3
    v_exp_f32 v32, v32
    v_exp_f32 v33, v33
    v_exp_f32 v34, v34
    v_mfma_f32_32x32x16_bf16 v[64:79], v[88:91], v[56:59], v[64:79]
    ds_read_b128 v[88:91], v3 offset:2560
    s_add_u32 s23, s23, 8192
    s_and_b32 s23, s23, 0xffff
    s_add_u32 s15, s53, s23
    s_add_u32 m0, s52, 49152
    s_nop 0
    buffer_load_dwordx4 v1, s[8:11], s15 offen sc1 lds
    v_cvt_pk_bf16_f32 v32, v32, v33
    v_exp_f32 v35, v35
    v_exp_f32 v36, v36
    v_exp_f32 v37, v37
    v_cvt_pk_bf16_f32 v33, v34, v35
    v_exp_f32 v38, v38
    v_exp_f32 v39, v39
    v_mfma_f32_32x32x16_bf16 v[48:63], v[80:83], v[4:7], v[16:31]
    ds_read_b128 v[80:83], v2 offset:4096
    s_waitcnt lgkmcnt(2)
    v_cvt_pk_bf16_f32 v34, v36, v37
    v_exp_f32 v40, v40
    v_exp_f32 v41, v41
    v_cvt_pk_bf16_f32 v35, v38, v39
    v_exp_f32 v42, v42
    v_exp_f32 v43, v43
    v_cvt_pk_bf16_f32 v40, v40, v41
    v_exp_f32 v44, v44
    v_mfma_f32_32x32x16_bf16 v[64:79], v[84:87], v[32:35], v[64:79]
    ds_read_b128 v[84:87], v3 offset:3072
    s_waitcnt lgkmcnt(1)
    s_add_u32 s15, s15, 65536
    s_add_u32 m0, s52, 114688
    s_nop 0
    buffer_load_dwordx4 v1, s[8:11], s15 offen sc1 lds
    v_exp_f32 v45, v45
    v_cvt_pk_bf16_f32 v41, v42, v43
    v_exp_f32 v46, v46
    v_exp_f32 v47, v47
    v_cvt_pk_bf16_f32 v42, v44, v45
    v_cvt_pk_bf16_f32 v43, v46, v47
    v_exp_f32 v48, v48
    v_exp_f32 v49, v49
    v_exp_f32 v50, v50
    v_mfma_f32_32x32x16_bf16 v[64:79], v[88:91], v[40:43], v[64:79]
    ds_read_b128 v[88:91], v3 offset:3584
    s_add_u32 s23, s23, 8192
    s_and_b32 s23, s23, 0xffff
    s_add_u32 s15, s53, s23
    s_add_u32 m0, s52, 57344
    s_nop 0
    buffer_load_dwordx4 v1, s[8:11], s15 offen sc1 lds
    v_cvt_pk_bf16_f32 v48, v48, v49
    v_exp_f32 v51, v51
    v_exp_f32 v52, v52
    v_exp_f32 v53, v53
    v_cvt_pk_bf16_f32 v49, v50, v51
    v_exp_f32 v54, v54
    v_exp_f32 v55, v55
    v_mfma_f32_32x32x16_bf16 v[32:47], v[80:83], v[4:7], v[16:31]
    ds_read_b128 v[80:83], v2 offset:5120
    s_waitcnt lgkmcnt(2)
    v_cvt_pk_bf16_f32 v50, v52, v53
    v_exp_f32 v56, v56
    v_exp_f32 v57, v57
    v_cvt_pk_bf16_f32 v51, v54, v55
    v_exp_f32 v58, v58
    v_exp_f32 v59, v59
    v_cvt_pk_bf16_f32 v56, v56, v57
    v_add_u32 v3, v3, v12
    v_exp_f32 v60, v60
    v_mfma_f32_32x32x16_bf16 v[64:79], v[84:87], v[48:51], v[64:79]
    ds_read_b128 v[84:87], v3 offset:0
    s_waitcnt lgkmcnt(1)
    s_add_u32 s15, s15, 65536
    s_add_u32 m0, s52, 122880
    s_nop 0
    buffer_load_dwordx4 v1, s[8:11], s15 offen sc1 lds
    v_exp_f32 v61, v61
    v_cvt_pk_bf16_f32 v57, v58, v59
    v_exp_f32 v62, v62
    v_add_u32 v2, 4096, v2
    v_exp_f32 v63, v63
    v_cvt_pk_bf16_f32 v58, v60, v61
    v_cvt_pk_bf16_f32 v59, v62, v63
    v_exp_f32 v32, v32
    v_exp_f32 v33, v33
    v_exp_f32 v34, v34
    v_mfma_f32_32x32x16_bf16 v[64:79], v[88:91], v[56:59], v[64:79]
    ds_read_b128 v[88:91], v3 offset:512
    s_cmp_lg_u32 s57, 0
    s_cbranch_scc1 ATT_p2
    s_mul_i32 s17, s49, 0
    buffer_store_dwordx4 v[92:95], v144, s[8:11], s17 offen sc1
    s_mul_i32 s17, s49, 1
    buffer_store_dwordx4 v[96:99], v144, s[8:11], s17 offen sc1
    s_mul_i32 s17, s49, 2
    buffer_store_dwordx4 v[100:103], v144, s[8:11], s17 offen sc1
    s_mul_i32 s17, s49, 3
    buffer_store_dwordx4 v[104:107], v144, s[8:11], s17 offen sc1
ATT_p2:
    v_cvt_pk_bf16_f32 v32, v32, v33
    v_exp_f32 v35, v35
    v_exp_f32 v36, v36
    v_exp_f32 v37, v37
    v_cvt_pk_bf16_f32 v33, v34, v35
    v_exp_f32 v38, v38
    v_exp_f32 v39, v39
    v_mfma_f32_32x32x16_bf16 v[48:63], v[80:83], v[4:7], v[16:31]
    ds_read_b128 v[80:83], v2 offset:2048
    s_waitcnt lgkmcnt(2)
    v_cvt_pk_bf16_f32 v34, v36, v37
    v_exp_f32 v40, v40
    v_exp_f32 v41, v41
    v_cvt_pk_bf16_f32 v35, v38, v39
    v_exp_f32 v42, v42
    v_exp_f32 v43, v43
    v_cvt_pk_bf16_f32 v40, v40, v41
    v_exp_f32 v44, v44
    v_mfma_f32_32x32x16_bf16 v[64:79], v[84:87], v[32:35], v[64:79]
    ds_read_b128 v[84:87], v3 offset:1024
    s_waitcnt lgkmcnt(1)
    s_and_b32 s17, s28, 0x18
    s_lshl_b32 s18, s33, 5
    s_add_u32 s17, s17, s18
    s_cmp_eq_u32 s17, 8
    s_cbranch_scc1 ATT_ewq
ATT_ewqd:
    v_exp_f32 v45, v45
    v_cvt_pk_bf16_f32 v41, v42, v43
    v_exp_f32 v46, v46
    v_exp_f32 v47, v47
    v_cvt_pk_bf16_f32 v42, v44, v45
    v_cvt_pk_bf16_f32 v43, v46, v47
    v_exp_f32 v48, v48
    v_exp_f32 v49, v49
    v_exp_f32 v50, v50
    v_mfma_f32_32x32x16_bf16 v[64:79], v[88:91], v[40:43], v[64:79]
    ds_read_b128 v[88:91], v3 offset:1536
    v_cvt_pk_bf16_f32 v48, v48, v49
    v_exp_f32 v51, v51
    v_exp_f32 v52, v52
    v_exp_f32 v53, v53
    v_cvt_pk_bf16_f32 v49, v50, v51
    v_exp_f32 v54, v54
    v_exp_f32 v55, v55
    v_mfma_f32_32x32x16_bf16 v[32:47], v[80:83], v[4:7], v[16:31]
    ds_read_b128 v[80:83], v2 offset:3072
    s_waitcnt lgkmcnt(2)
    v_cvt_pk_bf16_f32 v50, v52, v53
    v_exp_f32 v56, v56
    v_exp_f32 v57, v57
    v_cvt_pk_bf16_f32 v51, v54, v55
    v_exp_f32 v58, v58
    v_exp_f32 v59, v59
    v_cvt_pk_bf16_f32 v56, v56, v57
    v_exp_f32 v60, v60
    v_mfma_f32_32x32x16_bf16 v[64:79], v[84:87], v[48:51], v[64:79]
    ds_read_b128 v[84:87], v3 offset:2048
    s_waitcnt lgkmcnt(1)
    v_exp_f32 v61, v61
    v_cvt_pk_bf16_f32 v57, v58, v59
    v_exp_f32 v62, v62
    v_exp_f32 v63, v63
    v_cvt_pk_bf16_f32 v58, v60, v61
    v_cvt_pk_bf16_f32 v59, v62, v63
    s_setprio 2
    v_exp_f32 v32, v32
    v_exp_f32 v33, v33
    v_exp_f32 v34, v34
    v_mfma_f32_32x32x16_bf16 v[64:79], v[88:91], v[56:59], v[64:79]
    ds_read_b128 v[88:91], v3 offset:2560
    v_cvt_pk_bf16_f32 v32, v32, v33
    v_exp_f32 v35, v35
    v_exp_f32 v36, v36
    v_exp_f32 v37, v37
    v_cvt_pk_bf16_f32 v33, v34, v35
    v_exp_f32 v38, v38
    v_exp_f32 v39, v39
    v_mfma_f32_32x32x16_bf16 v[48:63], v[80:83], v[4:7], v[16:31]
    ds_read_b128 v[80:83], v2 offset:4096
    s_waitcnt lgkmcnt(2)
    v_cvt_pk_bf16_f32 v34, v36, v37
    v_exp_f32 v40, v40
    v_exp_f32 v41, v41
    v_cvt_pk_bf16_f32 v35, v38, v39
    v_exp_f32 v42, v42
    v_exp_f32 v43, v43
    v_cvt_pk_bf16_f32 v40, v40, v41
    v_exp_f32 v44, v44
    v_mfma_f32_32x32x16_bf16 v[64:79], v[84:87], v[32:35], v[64:79]
    ds_read_b128 v[84:87], v3 offset:3072
    s_waitcnt lgkmcnt(1)
    v_exp_f32 v45, v45
    v_cvt_pk_bf16_f32 v41, v42, v43
    v_exp_f32 v46, v46
    v_exp_f32 v47, v47
    v_cvt_pk_bf16_f32 v42, v44, v45
    v_cvt_pk_bf16_f32 v43, v46, v47
    v_exp_f32 v48, v48
    v_exp_f32 v49, v49
    v_exp_f32 v50, v50
    v_mfma_f32_32x32x16_bf16 v[64:79], v[88:91], v[40:43], v[64:79]
    ds_read_b128 v[88:91], v3 offset:3584
    v_cvt_pk_bf16_f32 v48, v48, v49
    v_exp_f32 v51, v51
    v_exp_f32 v52, v52
    v_exp_f32 v53, v53
    v_cvt_pk_bf16_f32 v49, v50, v51
    v_exp_f32 v54, v54
    v_exp_f32 v55, v55
    v_mfma_f32_32x32x16_bf16 v[32:47], v[80:83], v[4:7], v[16:31]
    ds_read_b128 v[80:83], v2 offset:5120
    s_waitcnt lgkmcnt(2)
    v_cvt_pk_bf16_f32 v50, v52, v53
    v_exp_f32 v56, v56
    v_exp_f32 v57, v57
    v_cvt_pk_bf16_f32 v51, v54, v55
    v_exp_f32 v58, v58
    v_exp_f32 v59, v59
    v_cvt_pk_bf16_f32 v56, v56, v57
    v_add_u32 v3, v3, v12
    v_exp_f32 v60, v60
    v_mfma_f32_32x32x16_bf16 v[64:79], v[84:87], v[48:51], v[64:79]
    ds_read_b128 v[84:87], v3 offset:0
    s_waitcnt lgkmcnt(1)
    v_exp_f32 v61, v61
    v_cvt_pk_bf16_f32 v57, v58, v59
    v_exp_f32 v62, v62
    v_add_u32 v2, 4096, v2
    v_exp_f32 v63, v63
    v_cvt_pk_bf16_f32 v58, v60, v61
    v_cvt_pk_bf16_f32 v59, v62, v63
    s_setprio 0
    v_exp_f32 v32, v32
    v_exp_f32 v33, v33
    v_exp_f32 v34, v34
    v_mfma_f32_32x32x16_bf16 v[64:79], v[88:91], v[56:59], v[64:79]
    ds_read_b128 v[88:91], v3 offset:512
    v_cvt_pk_bf16_f32 v32, v32, v33
    v_exp_f32 v35, v35
    v_exp_f32 v36, v36
    v_exp_f32 v37, v37
    v_cvt_pk_bf16_f32 v33, v34, v35
    v_exp_f32 v38, v38
    v_exp_f32 v39, v39
    v_mfma_f32_32x32x16_bf16 v[48:63], v[80:83], v[4:7], v[16:31]
    ds_read_b128 v[80:83], v2 offset:2048
    s_waitcnt lgkmcnt(2)
    v_cvt_pk_bf16_f32 v34, v36, v37
    v_exp_f32 v40, v40
    v_exp_f32 v41, v41
    v_cvt_pk_bf16_f32 v35, v38, v39
    v_exp_f32 v42, v42
    v_exp_f32 v43, v43
    v_cvt_pk_bf16_f32 v40, v40, v41
    v_exp_f32 v44, v44
    v_mfma_f32_32x32x16_bf16 v[64:79], v[84:87], v[32:35], v[64:79]
    ds_read_b128 v[84:87], v3 offset:1024
    s_waitcnt lgkmcnt(1)
    v_exp_f32 v45, v45
    v_cvt_pk_bf16_f32 v41, v42, v43
    v_exp_f32 v46, v46
    v_exp_f32 v47, v47
    v_cvt_pk_bf16_f32 v42, v44, v45
    v_cvt_pk_bf16_f32 v43, v46, v47
    s_waitcnt vmcnt(0)
    s_barrier
    s_setprio 3
    v_exp_f32 v48, v48
    v_exp_f32 v49, v49
    v_exp_f32 v50, v50
    v_mfma_f32_32x32x16_bf16 v[64:79], v[88:91], v[40:43], v[64:79]
    ds_read_b128 v[88:91], v3 offset:1536
    s_lshl_b32 s17, s33, 3
    s_add_u32 s17, s17, s3
    s_cmp_lg_u32 s17, 6
    s_cbranch_scc1 ATT_nw1
    v_mov_b32 v108, s32
    v_mov_b32 v109, 0
    s_lshr_b32 s17, s28, 3
    s_lshl_b32 s17, s17, 8
    s_and_b32 s18, s28, 7
    s_lshl_b32 s18, s18, 2
    s_add_u32 s17, s17, s18
    s_add_u32 s17, s17, 1581088
    s_mov_b64 exec, 1
    buffer_store_dword v108, v109, s[8:11], s17 offen sc1
    s_mov_b64 exec, -1
ATT_nw1:
    v_cvt_pk_bf16_f32 v48, v48, v49
    v_exp_f32 v51, v51
    v_exp_f32 v52, v52
    v_exp_f32 v53, v53
    v_cvt_pk_bf16_f32 v49, v50, v51
    v_exp_f32 v54, v54
    v_exp_f32 v55, v55
    v_mfma_f32_32x32x16_bf16 v[32:47], v[80:83], v[4:7], v[16:31]
    ds_read_b128 v[80:83], v2 offset:3072
    s_waitcnt lgkmcnt(2)
    v_cvt_pk_bf16_f32 v50, v52, v53
    v_exp_f32 v56, v56
    v_exp_f32 v57, v57
    v_cvt_pk_bf16_f32 v51, v54, v55
    v_exp_f32 v58, v58
    v_exp_f32 v59, v59
    v_cvt_pk_bf16_f32 v56, v56, v57
    v_exp_f32 v60, v60
    v_mfma_f32_32x32x16_bf16 v[64:79], v[84:87], v[48:51], v[64:79]
    ds_read_b128 v[84:87], v3 offset:2048
    s_waitcnt lgkmcnt(1)
    v_exp_f32 v61, v61
    v_cvt_pk_bf16_f32 v57, v58, v59
    v_exp_f32 v62, v62
    v_exp_f32 v63, v63
    v_cvt_pk_bf16_f32 v58, v60, v61
    v_cvt_pk_bf16_f32 v59, v62, v63
    v_exp_f32 v32, v32
    v_exp_f32 v33, v33
    v_exp_f32 v34, v34
    v_mfma_f32_32x32x16_bf16 v[64:79], v[88:91], v[56:59], v[64:79]
    ds_read_b128 v[88:91], v3 offset:2560
    v_cvt_pk_bf16_f32 v32, v32, v33
    v_exp_f32 v35, v35
    v_exp_f32 v36, v36
    v_exp_f32 v37, v37
    v_cvt_pk_bf16_f32 v33, v34, v35
    v_exp_f32 v38, v38
    v_exp_f32 v39, v39
    v_mfma_f32_32x32x16_bf16 v[48:63], v[80:83], v[4:7], v[16:31]
    ds_read_b128 v[80:83], v2 offset:4096
    s_waitcnt lgkmcnt(2)
    v_cvt_pk_bf16_f32 v34, v36, v37
    v_exp_f32 v40, v40
    v_exp_f32 v41, v41
    v_cvt_pk_bf16_f32 v35, v38, v39
    v_exp_f32 v42, v42
    v_exp_f32 v43, v43
    v_cvt_pk_bf16_f32 v40, v40, v41
    v_exp_f32 v44, v44
    v_mfma_f32_32x32x16_bf16 v[64:79], v[84:87], v[32:35], v[64:79]
    ds_read_b128 v[84:87], v3 offset:3072
    s_waitcnt lgkmcnt(1)
    v_exp_f32 v45, v45
    v_cvt_pk_bf16_f32 v41, v42, v43
    v_exp_f32 v46, v46
    v_exp_f32 v47, v47
    v_cvt_pk_bf16_f32 v42, v44, v45
    v_cvt_pk_bf16_f32 v43, v46, v47
    v_exp_f32 v48, v48
    v_exp_f32 v49, v49
    v_exp_f32 v50, v50
    v_mfma_f32_32x32x16_bf16 v[64:79], v[88:91], v[40:43], v[64:79]
    ds_read_b128 v[88:91], v3 offset:3584
    v_cvt_pk_bf16_f32 v48, v48, v49
    v_exp_f32 v51, v51
    v_exp_f32 v52, v52
    v_exp_f32 v53, v53
    v_cvt_pk_bf16_f32 v49, v50, v51
    v_exp_f32 v54, v54
    v_exp_f32 v55, v55
    v_mfma_f32_32x32x16_bf16 v[32:47], v[80:83], v[4:7], v[16:31]
    ds_read_b128 v[80:83], v2 offset:5120
    s_waitcnt lgkmcnt(2)
    v_cvt_pk_bf16_f32 v50, v52, v53
    v_exp_f32 v56, v56
    v_exp_f32 v57, v57
    v_cvt_pk_bf16_f32 v51, v54, v55
    v_exp_f32 v58, v58
    v_exp_f32 v59, v59
    v_cvt_pk_bf16_f32 v56, v56, v57
    v_add_u32 v3, v3, v12
    v_exp_f32 v60, v60
    v_mfma_f32_32x32x16_bf16 v[64:79], v[84:87], v[48:51], v[64:79]
    ds_read_b128 v[84:87], v3 offset:0
    s_waitcnt lgkmcnt(1)
    v_exp_f32 v61, v61
    v_cvt_pk_bf16_f32 v57, v58, v59
    v_exp_f32 v62, v62
    v_add_u32 v2, 4096, v2
    v_exp_f32 v63, v63
    v_cvt_pk_bf16_f32 v58, v60, v61
    v_cvt_pk_bf16_f32 v59, v62, v63
    v_exp_f32 v32, v32
    v_exp_f32 v33, v33
    v_exp_f32 v34, v34
    v_mfma_f32_32x32x16_bf16 v[64:79], v[88:91], v[56:59], v[64:79]
    ds_read_b128 v[88:91], v3 offset:512
    v_cvt_pk_bf16_f32 v32, v32, v33
    v_exp_f32 v35, v35
    v_exp_f32 v36, v36
    v_exp_f32 v37, v37
    v_cvt_pk_bf16_f32 v33, v34, v35
    v_exp_f32 v38, v38
    v_exp_f32 v39, v39
    v_mfma_f32_32x32x16_bf16 v[48:63], v[80:83], v[4:7], v[16:31]
    ds_read_b128 v[80:83], v2 offset:2048
    s_waitcnt lgkmcnt(2)
    v_cvt_pk_bf16_f32 v34, v36, v37
    v_exp_f32 v40, v40
    v_exp_f32 v41, v41
    v_cvt_pk_bf16_f32 v35, v38, v39
    v_exp_f32 v42, v42
    v_exp_f32 v43, v43
    v_cvt_pk_bf16_f32 v40, v40, v41
    v_exp_f32 v44, v44
    v_mfma_f32_32x32x16_bf16 v[64:79], v[84:87], v[32:35], v[64:79]
    ds_read_b128 v[84:87], v3 offset:1024
    s_waitcnt lgkmcnt(1)
    v_exp_f32 v45, v45
    v_cvt_pk_bf16_f32 v41, v42, v43
    v_exp_f32 v46, v46
    v_exp_f32 v47, v47
    v_cvt_pk_bf16_f32 v42, v44, v45
    v_cvt_pk_bf16_f32 v43, v46, v47
    s_setprio 2
    v_exp_f32 v48, v48
    v_exp_f32 v49, v49
    v_exp_f32 v50, v50
    v_mfma_f32_32x32x16_bf16 v[64:79], v[88:91], v[40:43], v[64:79]
    ds_read_b128 v[88:91], v3 offset:1536
    s_lshl_b32 s18, s33, 3
    s_add_u32 s18, s18, s3
    s_cmp_lg_u32 s18, 7
    s_cbranch_scc1 ATT_p_l
    buffer_load_dwordx4 v[116:119], v121, s[8:11], s60 offen offset:32 sc1
ATT_p_l:
    v_cvt_pk_bf16_f32 v48, v48, v49
    v_exp_f32 v51, v51
    v_exp_f32 v52, v52
    v_exp_f32 v53, v53
    v_cvt_pk_bf16_f32 v49, v50, v51
    v_exp_f32 v54, v54
    v_exp_f32 v55, v55
    v_mfma_f32_32x32x16_bf16 v[32:47], v[80:83], v[4:7], v[16:31]
    ds_read_b128 v[80:83], v2 offset:3072
    s_waitcnt lgkmcnt(2)
    v_cvt_pk_bf16_f32 v50, v52, v53
    v_exp_f32 v56, v56
    v_exp_f32 v57, v57
    v_cvt_pk_bf16_f32 v51, v54, v55
    v_exp_f32 v58, v58
    v_exp_f32 v59, v59
    v_cvt_pk_bf16_f32 v56, v56, v57
    v_exp_f32 v60, v60
    v_mfma_f32_32x32x16_bf16 v[64:79], v[84:87], v[48:51], v[64:79]
    ds_read_b128 v[84:87], v3 offset:2048
    s_waitcnt lgkmcnt(1)
    v_exp_f32 v61, v61
    v_cvt_pk_bf16_f32 v57, v58, v59
    v_exp_f32 v62, v62
    v_exp_f32 v63, v63
    v_cvt_pk_bf16_f32 v58, v60, v61
    v_cvt_pk_bf16_f32 v59, v62, v63
    s_setprio 0
    v_exp_f32 v32, v32
    v_exp_f32 v33, v33
    v_exp_f32 v34, v34
    v_mfma_f32_32x32x16_bf16 v[64:79], v[88:91], v[56:59], v[64:79]
    ds_read_b128 v[88:91], v3 offset:2560
    v_cvt_pk_bf16_f32 v32, v32, v33
    v_exp_f32 v35, v35
    v_exp_f32 v36, v36
    v_exp_f32 v37, v37
    v_cvt_pk_bf16_f32 v33, v34, v35
    v_exp_f32 v38, v38
    v_exp_f32 v39, v39
    v_mfma_f32_32x32x16_bf16 v[48:63], v[80:83], v[4:7], v[16:31]
    ds_read_b128 v[80:83], v2 offset:4096
    s_waitcnt lgkmcnt(2)
    v_cvt_pk_bf16_f32 v34, v36, v37
    v_exp_f32 v40, v40
    v_exp_f32 v41, v41
    v_cvt_pk_bf16_f32 v35, v38, v39
    v_exp_f32 v42, v42
    v_exp_f32 v43, v43
    v_cvt_pk_bf16_f32 v40, v40, v41
    v_exp_f32 v44, v44
    v_mfma_f32_32x32x16_bf16 v[64:79], v[84:87], v[32:35], v[64:79]
    ds_read_b128 v[84:87], v3 offset:3072
    s_waitcnt lgkmcnt(1)
    v_exp_f32 v45, v45
    v_cvt_pk_bf16_f32 v41, v42, v43
    v_exp_f32 v46, v46
    v_exp_f32 v47, v47
    v_cvt_pk_bf16_f32 v42, v44, v45
    v_cvt_pk_bf16_f32 v43, v46, v47
    s_lshl_b32 s18, s33, 3
    s_add_u32 s18, s18, s3
    s_cmp_lg_u32 s18, 7
    s_cbranch_scc1 ATT_p_ok
    s_waitcnt vmcnt(0)
    v_min_u32 v116, v116, v117
    v_min3_u32 v116, v116, v118, v119
    v_cmp_gt_u32 vcc, s32, v116
    s_nop 0
    s_cbranch_vccnz ATT_p_s
ATT_p_ok:
    s_cmp_lg_u32 s33, 0
    s_cbranch_scc1 ATT_ntp19
    s_barrier
ATT_ntp19:
    s_setprio 3
    v_exp_f32 v48, v48
    v_exp_f32 v49, v49
    v_exp_f32 v50, v50
    v_mfma_f32_32x32x16_bf16 v[64:79], v[88:91], v[40:43], v[64:79]
    ds_read_b128 v[88:91], v3 offset:3584
    buffer_load_dwordx4 v[156:159], v1, s[8:11], s36 offen offset:0
    v_cvt_pk_bf16_f32 v48, v48, v49
    v_exp_f32 v51, v51
    v_exp_f32 v52, v52
    v_exp_f32 v53, v53
    v_cvt_pk_bf16_f32 v49, v50, v51
    v_exp_f32 v54, v54
    v_exp_f32 v55, v55
    v_mfma_f32_32x32x16_bf16 v[32:47], v[80:83], v[4:7], v[16:31]
    ds_read_b128 v[80:83], v2 offset:5120
    s_waitcnt lgkmcnt(2)
    v_cvt_pk_bf16_f32 v50, v52, v53
    v_exp_f32 v56, v56
    v_exp_f32 v57, v57
    v_cvt_pk_bf16_f32 v51, v54, v55
    v_exp_f32 v58, v58
    v_exp_f32 v59, v59
    v_cvt_pk_bf16_f32 v56, v56, v57
    v_add_u32 v3, v3, v12
    v_exp_f32 v60, v60
    v_mfma_f32_32x32x16_bf16 v[64:79], v[84:87], v[48:51], v[64:79]
    ds_read_b128 v[84:87], v3 offset:0
    s_waitcnt lgkmcnt(1)
    v_exp_f32 v61, v61
    v_cvt_pk_bf16_f32 v57, v58, v59
    v_exp_f32 v62, v62
    v_add_u32 v2, 4096, v2
    v_exp_f32 v63, v63
    v_cvt_pk_bf16_f32 v58, v60, v61
    v_cvt_pk_bf16_f32 v59, v62, v63
    v_exp_f32 v32, v32
    v_exp_f32 v33, v33
    v_exp_f32 v34, v34
    v_mfma_f32_32x32x16_bf16 v[64:79], v[88:91], v[56:59], v[64:79]
    ds_read_b128 v[88:91], v3 offset:512
    buffer_load_dwordx4 v[160:163], v1, s[8:11], s36 offen offset:1024
    v_cvt_pk_bf16_f32 v32, v32, v33
    v_exp_f32 v35, v35
    v_exp_f32 v36, v36
    v_exp_f32 v37, v37
    v_cvt_pk_bf16_f32 v33, v34, v35
    v_exp_f32 v38, v38
    v_exp_f32 v39, v39
    v_mfma_f32_32x32x16_bf16 v[48:63], v[80:83], v[4:7], v[16:31]
    ds_read_b128 v[80:83], v2 offset:2048
    s_waitcnt lgkmcnt(2)
    v_cvt_pk_bf16_f32 v34, v36, v37
    v_exp_f32 v40, v40
    v_exp_f32 v41, v41
    v_cvt_pk_bf16_f32 v35, v38, v39
    v_exp_f32 v42, v42
    v_exp_f32 v43, v43
    v_cvt_pk_bf16_f32 v40, v40, v41
    v_exp_f32 v44, v44
    v_mfma_f32_32x32x16_bf16 v[64:79], v[84:87], v[32:35], v[64:79]
    ds_read_b128 v[84:87], v3 offset:1024
    s_waitcnt lgkmcnt(1)
    v_exp_f32 v45, v45
    v_cvt_pk_bf16_f32 v41, v42, v43
    v_exp_f32 v46, v46
    v_exp_f32 v47, v47
    v_cvt_pk_bf16_f32 v42, v44, v45
    v_cvt_pk_bf16_f32 v43, v46, v47
    v_exp_f32 v48, v48
    v_exp_f32 v49, v49
    v_exp_f32 v50, v50
    v_mfma_f32_32x32x16_bf16 v[64:79], v[88:91], v[40:43], v[64:79]
    ds_read_b128 v[88:91], v3 offset:1536
    buffer_load_dwordx4 v[164:167], v1, s[8:11], s36 offen offset:2048
    v_cvt_pk_bf16_f32 v48, v48, v49
    v_exp_f32 v51, v51
    v_exp_f32 v52, v52
    v_exp_f32 v53, v53
    v_cvt_pk_bf16_f32 v49, v50, v51
    v_exp_f32 v54, v54
    v_exp_f32 v55, v55
    v_mfma_f32_32x32x16_bf16 v[32:47], v[80:83], v[4:7], v[16:31]
    ds_read_b128 v[80:83], v2 offset:3072
    s_waitcnt lgkmcnt(2)
    v_cvt_pk_bf16_f32 v50, v52, v53
    v_exp_f32 v56, v56
    v_exp_f32 v57, v57
    v_cvt_pk_bf16_f32 v51, v54, v55
    v_exp_f32 v58, v58
    v_exp_f32 v59, v59
    v_cvt_pk_bf16_f32 v56, v56, v57
    v_exp_f32 v60, v60
    v_mfma_f32_32x32x16_bf16 v[64:79], v[84:87], v[48:51], v[64:79]
    ds_read_b128 v[84:87], v3 offset:2048
    s_waitcnt lgkmcnt(1)
    v_exp_f32 v61, v61
    v_cvt_pk_bf16_f32 v57, v58, v59
    v_exp_f32 v62, v62
    v_exp_f32 v63, v63
    v_cvt_pk_bf16_f32 v58, v60, v61
    v_cvt_pk_bf16_f32 v59, v62, v63
    v_exp_f32 v32, v32
    v_exp_f32 v33, v33
    v_exp_f32 v34, v34
    v_mfma_f32_32x32x16_bf16 v[64:79], v[88:91], v[56:59], v[64:79]
    ds_read_b128 v[88:91], v3 offset:2560
    buffer_load_dwordx4 v[168:171], v1, s[8:11], s36 offen offset:3072
    v_cvt_pk_bf16_f32 v32, v32, v33
    v_exp_f32 v35, v35
    v_exp_f32 v36, v36
    v_exp_f32 v37, v37
    v_cvt_pk_bf16_f32 v33, v34, v35
    v_exp_f32 v38, v38
    v_exp_f32 v39, v39
    v_mfma_f32_32x32x16_bf16 v[48:63], v[80:83], v[4:7], v[16:31]
    ds_read_b128 v[80:83], v2 offset:4096
    s_waitcnt lgkmcnt(2)
    v_cvt_pk_bf16_f32 v34, v36, v37
    v_exp_f32 v40, v40
    v_exp_f32 v41, v41
    v_cvt_pk_bf16_f32 v35, v38, v39
    v_exp_f32 v42, v42
    v_exp_f32 v43, v43
    v_cvt_pk_bf16_f32 v40, v40, v41
    v_exp_f32 v44, v44
    v_mfma_f32_32x32x16_bf16 v[64:79], v[84:87], v[32:35], v[64:79]
    ds_read_b128 v[84:87], v3 offset:3072
    s_waitcnt lgkmcnt(1)
    v_exp_f32 v45, v45
    v_cvt_pk_bf16_f32 v41, v42, v43
    v_exp_f32 v46, v46
    v_exp_f32 v47, v47
    v_cvt_pk_bf16_f32 v42, v44, v45
    v_cvt_pk_bf16_f32 v43, v46, v47
    v_exp_f32 v48, v48
    v_exp_f32 v49, v49
    v_exp_f32 v50, v50
    v_mfma_f32_32x32x16_bf16 v[64:79], v[88:91], v[40:43], v[64:79]
    ds_read_b128 v[88:91], v3 offset:3584
    s_add_u32 s19, s36, 4096
    buffer_load_dwordx4 v[172:175], v1, s[8:11], s19 offen offset:0
    v_cvt_pk_bf16_f32 v48, v48, v49
    v_exp_f32 v51, v51
    v_exp_f32 v52, v52
    v_exp_f32 v53, v53
    v_cvt_pk_bf16_f32 v49, v50, v51
    v_exp_f32 v54, v54
    v_exp_f32 v55, v55
    v_mfma_f32_32x32x16_bf16 v[32:47], v[80:83], v[4:7], v[16:31]
    ds_read_b128 v[80:83], v2 offset:5120
    s_waitcnt lgkmcnt(2)
    v_cvt_pk_bf16_f32 v50, v52, v53
    v_exp_f32 v56, v56
    v_exp_f32 v57, v57
    v_cvt_pk_bf16_f32 v51, v54, v55
    v_exp_f32 v58, v58
    v_exp_f32 v59, v59
    v_cvt_pk_bf16_f32 v56, v56, v57
    v_add_u32 v3, v3, v12
    v_exp_f32 v60, v60
    v_mfma_f32_32x32x16_bf16 v[64:79], v[84:87], v[48:51], v[64:79]
    ds_read_b128 v[84:87], v3 offset:0
    s_waitcnt lgkmcnt(1)
    v_exp_f32 v61, v61
    v_cvt_pk_bf16_f32 v57, v58, v59
    v_exp_f32 v62, v62
    v_add_u32 v2, 4096, v2
    v_exp_f32 v63, v63
    v_cvt_pk_bf16_f32 v58, v60, v61
    v_cvt_pk_bf16_f32 v59, v62, v63
    v_exp_f32 v32, v32
    v_exp_f32 v33, v33
    v_exp_f32 v34, v34
    v_mfma_f32_32x32x16_bf16 v[64:79], v[88:91], v[56:59], v[64:79]
    ds_read_b128 v[88:91], v3 offset:512
    s_add_u32 s19, s36, 4096
    buffer_load_dwordx4 v[176:179], v1, s[8:11], s19 offen offset:1024
    v_cvt_pk_bf16_f32 v32, v32, v33
    v_exp_f32 v35, v35
    v_exp_f32 v36, v36
    v_exp_f32 v37, v37
    v_cvt_pk_bf16_f32 v33, v34, v35
    v_exp_f32 v38, v38
    v_exp_f32 v39, v39
    v_mfma_f32_32x32x16_bf16 v[48:63], v[80:83], v[4:7], v[16:31]
    ds_read_b128 v[80:83], v2 offset:2048
    s_waitcnt lgkmcnt(2)
    v_cvt_pk_bf16_f32 v34, v36, v37
    v_exp_f32 v40, v40
    v_exp_f32 v41, v41
    v_cvt_pk_bf16_f32 v35, v38, v39
    v_exp_f32 v42, v42
    v_exp_f32 v43, v43
    v_cvt_pk_bf16_f32 v40, v40, v41
    v_exp_f32 v44, v44
    v_mfma_f32_32x32x16_bf16 v[64:79], v[84:87], v[32:35], v[64:79]
    ds_read_b128 v[84:87], v3 offset:1024
    s_waitcnt lgkmcnt(1)
    v_exp_f32 v45, v45
    v_cvt_pk_bf16_f32 v41, v42, v43
    v_exp_f32 v46, v46
    v_exp_f32 v47, v47
    v_cvt_pk_bf16_f32 v42, v44, v45
    v_cvt_pk_bf16_f32 v43, v46, v47
    v_exp_f32 v48, v48
    v_exp_f32 v49, v49
    v_exp_f32 v50, v50
    v_mfma_f32_32x32x16_bf16 v[64:79], v[88:91], v[40:43], v[64:79]
    ds_read_b128 v[88:91], v3 offset:1536
    s_add_u32 s19, s36, 4096
    buffer_load_dwordx4 v[180:183], v1, s[8:11], s19 offen offset:2048
    v_cvt_pk_bf16_f32 v48, v48, v49
    v_exp_f32 v51, v51
    v_exp_f32 v52, v52
    v_exp_f32 v53, v53
    v_cvt_pk_bf16_f32 v49, v50, v51
    v_exp_f32 v54, v54
    v_exp_f32 v55, v55
    v_mfma_f32_32x32x16_bf16 v[32:47], v[80:83], v[4:7], v[16:31]
    ds_read_b128 v[80:83], v2 offset:3072
    s_waitcnt lgkmcnt(2)
    v_cvt_pk_bf16_f32 v50, v52, v53
    v_exp_f32 v56, v56
    v_exp_f32 v57, v57
    v_cvt_pk_bf16_f32 v51, v54, v55
    v_exp_f32 v58, v58
    v_exp_f32 v59, v59
    v_cvt_pk_bf16_f32 v56, v56, v57
    v_exp_f32 v60, v60
    v_mfma_f32_32x32x16_bf16 v[64:79], v[84:87], v[48:51], v[64:79]
    ds_read_b128 v[84:87], v3 offset:2048
    s_waitcnt lgkmcnt(1)
    v_exp_f32 v61, v61
    v_cvt_pk_bf16_f32 v57, v58, v59
    v_exp_f32 v62, v62
    v_exp_f32 v63, v63
    v_cvt_pk_bf16_f32 v58, v60, v61
    v_cvt_pk_bf16_f32 v59, v62, v63
    v_exp_f32 v32, v32
    v_exp_f32 v33, v33
    v_exp_f32 v34, v34
    v_mfma_f32_32x32x16_bf16 v[64:79], v[88:91], v[56:59], v[64:79]
    ds_read_b128 v[88:91], v3 offset:2560
    s_add_u32 s19, s36, 4096
    buffer_load_dwordx4 v[184:187], v1, s[8:11], s19 offen offset:3072
    v_cvt_pk_bf16_f32 v32, v32, v33
    v_exp_f32 v35, v35
    v_exp_f32 v36, v36
    v_exp_f32 v37, v37
    v_cvt_pk_bf16_f32 v33, v34, v35
    v_exp_f32 v38, v38
    v_exp_f32 v39, v39
    v_mfma_f32_32x32x16_bf16 v[48:63], v[80:83], v[4:7], v[16:31]
    ds_read_b128 v[80:83], v2 offset:4096
    s_waitcnt lgkmcnt(2)
    v_cvt_pk_bf16_f32 v34, v36, v37
    v_exp_f32 v40, v40
    v_exp_f32 v41, v41
    v_cvt_pk_bf16_f32 v35, v38, v39
    v_exp_f32 v42, v42
    v_exp_f32 v43, v43
    v_cvt_pk_bf16_f32 v40, v40, v41
    v_exp_f32 v44, v44
    v_mfma_f32_32x32x16_bf16 v[64:79], v[84:87], v[32:35], v[64:79]
    ds_read_b128 v[84:87], v3 offset:3072
    s_waitcnt lgkmcnt(1)
    v_exp_f32 v45, v45
    v_cvt_pk_bf16_f32 v41, v42, v43
    v_exp_f32 v46, v46
    v_exp_f32 v47, v47
    v_cvt_pk_bf16_f32 v42, v44, v45
    v_cvt_pk_bf16_f32 v43, v46, v47
    v_exp_f32 v48, v48
    v_exp_f32 v49, v49
    v_exp_f32 v50, v50
    v_mfma_f32_32x32x16_bf16 v[64:79], v[88:91], v[40:43], v[64:79]
    ds_read_b128 v[88:91], v3 offset:3584
    s_add_u32 s19, s36, 8192
    buffer_load_dwordx4 v[188:191], v1, s[8:11], s19 offen offset:0
    v_cvt_pk_bf16_f32 v48, v48, v49
    v_exp_f32 v51, v51
    v_exp_f32 v52, v52
    v_exp_f32 v53, v53
    v_cvt_pk_bf16_f32 v49, v50, v51
    v_exp_f32 v54, v54
    v_exp_f32 v55, v55
    v_mfma_f32_32x32x16_bf16 v[32:47], v[80:83], v[4:7], v[16:31]
    ds_read_b128 v[80:83], v2 offset:5120
    s_waitcnt lgkmcnt(2)
    v_cvt_pk_bf16_f32 v50, v52, v53
    v_exp_f32 v56, v56
    v_exp_f32 v57, v57
    v_cvt_pk_bf16_f32 v51, v54, v55
    v_exp_f32 v58, v58
    v_exp_f32 v59, v59
    v_cvt_pk_bf16_f32 v56, v56, v57
    v_add_u32 v3, v3, v12
    v_exp_f32 v60, v60
    v_mfma_f32_32x32x16_bf16 v[64:79], v[84:87], v[48:51], v[64:79]
    ds_read_b128 v[84:87], v3 offset:0
    s_waitcnt lgkmcnt(1)
    v_exp_f32 v61, v61
    v_cvt_pk_bf16_f32 v57, v58, v59
    v_exp_f32 v62, v62
    v_add_u32 v2, 4096, v2
    v_exp_f32 v63, v63
    v_cvt_pk_bf16_f32 v58, v60, v61
    v_cvt_pk_bf16_f32 v59, v62, v63
    v_exp_f32 v32, v32
    v_exp_f32 v33, v33
    v_exp_f32 v34, v34
    v_mfma_f32_32x32x16_bf16 v[64:79], v[88:91], v[56:59], v[64:79]
    ds_read_b128 v[88:91], v3 offset:512
    s_add_u32 s19, s36, 8192
    buffer_load_dwordx4 v[192:195], v1, s[8:11], s19 offen offset:1024
    v_cvt_pk_bf16_f32 v32, v32, v33
    v_exp_f32 v35, v35
    v_exp_f32 v36, v36
    v_exp_f32 v37, v37
    v_cvt_pk_bf16_f32 v33, v34, v35
    v_exp_f32 v38, v38
    v_exp_f32 v39, v39
    v_mfma_f32_32x32x16_bf16 v[48:63], v[80:83], v[4:7], v[16:31]
    ds_read_b128 v[80:83], v2 offset:2048
    s_waitcnt lgkmcnt(2)
    v_cvt_pk_bf16_f32 v34, v36, v37
    v_exp_f32 v40, v40
    v_exp_f32 v41, v41
    v_cvt_pk_bf16_f32 v35, v38, v39
    v_exp_f32 v42, v42
    v_exp_f32 v43, v43
    v_cvt_pk_bf16_f32 v40, v40, v41
    v_exp_f32 v44, v44
    v_mfma_f32_32x32x16_bf16 v[64:79], v[84:87], v[32:35], v[64:79]
    ds_read_b128 v[84:87], v3 offset:1024
    s_waitcnt lgkmcnt(1)
    v_exp_f32 v45, v45
    v_cvt_pk_bf16_f32 v41, v42, v43
    v_exp_f32 v46, v46
    v_exp_f32 v47, v47
    v_cvt_pk_bf16_f32 v42, v44, v45
    v_cvt_pk_bf16_f32 v43, v46, v47
    v_exp_f32 v48, v48
    v_exp_f32 v49, v49
    v_exp_f32 v50, v50
    v_mfma_f32_32x32x16_bf16 v[64:79], v[88:91], v[40:43], v[64:79]
    ds_read_b128 v[88:91], v3 offset:1536
    s_add_u32 s19, s36, 8192
    buffer_load_dwordx4 v[196:199], v1, s[8:11], s19 offen offset:2048
    v_cvt_pk_bf16_f32 v48, v48, v49
    v_exp_f32 v51, v51
    v_exp_f32 v52, v52
    v_exp_f32 v53, v53
    v_cvt_pk_bf16_f32 v49, v50, v51
    v_exp_f32 v54, v54
    v_exp_f32 v55, v55
    v_mfma_f32_32x32x16_bf16 v[32:47], v[80:83], v[4:7], v[16:31]
    ds_read_b128 v[80:83], v2 offset:3072
    s_waitcnt lgkmcnt(2)
    v_cvt_pk_bf16_f32 v50, v52, v53
    v_exp_f32 v56, v56
    v_exp_f32 v57, v57
    v_cvt_pk_bf16_f32 v51, v54, v55
    v_exp_f32 v58, v58
    v_exp_f32 v59, v59
    v_cvt_pk_bf16_f32 v56, v56, v57
    v_exp_f32 v60, v60
    v_mfma_f32_32x32x16_bf16 v[64:79], v[84:87], v[48:51], v[64:79]
    ds_read_b128 v[84:87], v3 offset:2048
    s_waitcnt lgkmcnt(1)
    v_exp_f32 v61, v61
    v_cvt_pk_bf16_f32 v57, v58, v59
    v_exp_f32 v62, v62
    v_exp_f32 v63, v63
    v_cvt_pk_bf16_f32 v58, v60, v61
    v_cvt_pk_bf16_f32 v59, v62, v63
    v_exp_f32 v32, v32
    v_exp_f32 v33, v33
    v_exp_f32 v34, v34
    v_mfma_f32_32x32x16_bf16 v[64:79], v[88:91], v[56:59], v[64:79]
    ds_read_b128 v[88:91], v3 offset:2560
    s_add_u32 s19, s36, 8192
    buffer_load_dwordx4 v[200:203], v1, s[8:11], s19 offen offset:3072
    v_cvt_pk_bf16_f32 v32, v32, v33
    v_exp_f32 v35, v35
    v_exp_f32 v36, v36
    v_exp_f32 v37, v37
    v_cvt_pk_bf16_f32 v33, v34, v35
    v_exp_f32 v38, v38
    v_exp_f32 v39, v39
    v_mfma_f32_32x32x16_bf16 v[48:63], v[80:83], v[4:7], v[16:31]
    ds_read_b128 v[80:83], v2 offset:4096
    s_waitcnt lgkmcnt(2)
    v_cvt_pk_bf16_f32 v34, v36, v37
    v_exp_f32 v40, v40
    v_exp_f32 v41, v41
    v_cvt_pk_bf16_f32 v35, v38, v39
    v_exp_f32 v42, v42
    v_exp_f32 v43, v43
    v_cvt_pk_bf16_f32 v40, v40, v41
    v_exp_f32 v44, v44
    v_mfma_f32_32x32x16_bf16 v[64:79], v[84:87], v[32:35], v[64:79]
    ds_read_b128 v[84:87], v3 offset:3072
    s_waitcnt lgkmcnt(1)
    v_exp_f32 v45, v45
    v_cvt_pk_bf16_f32 v41, v42, v43
    v_exp_f32 v46, v46
    v_exp_f32 v47, v47
    v_cvt_pk_bf16_f32 v42, v44, v45
    v_cvt_pk_bf16_f32 v43, v46, v47
    v_exp_f32 v48, v48
    v_exp_f32 v49, v49
    v_exp_f32 v50, v50
    v_mfma_f32_32x32x16_bf16 v[64:79], v[88:91], v[40:43], v[64:79]
    ds_read_b128 v[88:91], v3 offset:3584
    s_add_u32 s19, s36, 12288
    buffer_load_dwordx4 v[204:207], v1, s[8:11], s19 offen offset:0
    v_cvt_pk_bf16_f32 v48, v48, v49
    v_exp_f32 v51, v51
    v_exp_f32 v52, v52
    v_exp_f32 v53, v53
    v_cvt_pk_bf16_f32 v49, v50, v51
    v_exp_f32 v54, v54
    v_exp_f32 v55, v55
    v_mfma_f32_32x32x16_bf16 v[32:47], v[80:83], v[4:7], v[16:31]
    ds_read_b128 v[80:83], v2 offset:5120
    s_waitcnt lgkmcnt(2)
    v_cvt_pk_bf16_f32 v50, v52, v53
    v_exp_f32 v56, v56
    v_exp_f32 v57, v57
    v_cvt_pk_bf16_f32 v51, v54, v55
    v_exp_f32 v58, v58
    v_exp_f32 v59, v59
    v_cvt_pk_bf16_f32 v56, v56, v57
    v_add_u32 v3, v3, v12
    v_exp_f32 v60, v60
    v_mfma_f32_32x32x16_bf16 v[64:79], v[84:87], v[48:51], v[64:79]
    ds_read_b128 v[84:87], v3 offset:0
    s_waitcnt lgkmcnt(1)
    v_exp_f32 v61, v61
    v_cvt_pk_bf16_f32 v57, v58, v59
    v_exp_f32 v62, v62
    v_add_u32 v2, 4096, v2
    v_exp_f32 v63, v63
    v_cvt_pk_bf16_f32 v58, v60, v61
    v_cvt_pk_bf16_f32 v59, v62, v63
    v_exp_f32 v32, v32
    v_exp_f32 v33, v33
    v_exp_f32 v34, v34
    v_mfma_f32_32x32x16_bf16 v[64:79], v[88:91], v[56:59], v[64:79]
    ds_read_b128 v[88:91], v3 offset:512
    s_add_u32 s19, s36, 12288
    buffer_load_dwordx4 v[208:211], v1, s[8:11], s19 offen offset:1024
    v_cvt_pk_bf16_f32 v32, v32, v33
    v_exp_f32 v35, v35
    v_exp_f32 v36, v36
    v_exp_f32 v37, v37
    v_cvt_pk_bf16_f32 v33, v34, v35
    v_exp_f32 v38, v38
    v_exp_f32 v39, v39
    v_mfma_f32_32x32x16_bf16 v[48:63], v[80:83], v[4:7], v[16:31]
    ds_read_b128 v[80:83], v2 offset:2048
    s_waitcnt lgkmcnt(2)
    v_cvt_pk_bf16_f32 v34, v36, v37
    v_exp_f32 v40, v40
    v_exp_f32 v41, v41
    v_cvt_pk_bf16_f32 v35, v38, v39
    v_exp_f32 v42, v42
    v_exp_f32 v43, v43
    v_cvt_pk_bf16_f32 v40, v40, v41
    v_exp_f32 v44, v44
    v_mfma_f32_32x32x16_bf16 v[64:79], v[84:87], v[32:35], v[64:79]
    ds_read_b128 v[84:87], v3 offset:1024
    s_waitcnt lgkmcnt(1)
    v_exp_f32 v45, v45
    v_cvt_pk_bf16_f32 v41, v42, v43
    v_exp_f32 v46, v46
    v_exp_f32 v47, v47
    v_cvt_pk_bf16_f32 v42, v44, v45
    v_cvt_pk_bf16_f32 v43, v46, v47
    v_exp_f32 v48, v48
    v_exp_f32 v49, v49
    v_exp_f32 v50, v50
    v_mfma_f32_32x32x16_bf16 v[64:79], v[88:91], v[40:43], v[64:79]
    ds_read_b128 v[88:91], v3 offset:1536
    s_add_u32 s19, s36, 12288
    buffer_load_dwordx4 v[212:215], v1, s[8:11], s19 offen offset:2048
    v_cvt_pk_bf16_f32 v48, v48, v49
    v_exp_f32 v51, v51
    v_exp_f32 v52, v52
    v_exp_f32 v53, v53
    v_cvt_pk_bf16_f32 v49, v50, v51
    v_exp_f32 v54, v54
    v_exp_f32 v55, v55
    v_mfma_f32_32x32x16_bf16 v[32:47], v[80:83], v[4:7], v[16:31]
    ds_read_b128 v[80:83], v2 offset:3072
    s_waitcnt lgkmcnt(2)
    v_cvt_pk_bf16_f32 v50, v52, v53
    v_exp_f32 v56, v56
    v_exp_f32 v57, v57
    v_cvt_pk_bf16_f32 v51, v54, v55
    v_exp_f32 v58, v58
    v_exp_f32 v59, v59
    v_cvt_pk_bf16_f32 v56, v56, v57
    v_exp_f32 v60, v60
    v_mfma_f32_32x32x16_bf16 v[64:79], v[84:87], v[48:51], v[64:79]
    ds_read_b128 v[84:87], v3 offset:2048
    s_waitcnt lgkmcnt(1)
    v_exp_f32 v61, v61
    v_cvt_pk_bf16_f32 v57, v58, v59
    v_exp_f32 v62, v62
    v_exp_f32 v63, v63
    v_cvt_pk_bf16_f32 v58, v60, v61
    v_cvt_pk_bf16_f32 v59, v62, v63
    v_exp_f32 v32, v32
    v_exp_f32 v33, v33
    v_exp_f32 v34, v34
    v_mfma_f32_32x32x16_bf16 v[64:79], v[88:91], v[56:59], v[64:79]
    ds_read_b128 v[88:91], v3 offset:2560
    s_add_u32 s19, s36, 12288
    buffer_load_dwordx4 v[216:219], v1, s[8:11], s19 offen offset:3072
    v_cvt_pk_bf16_f32 v32, v32, v33
    v_exp_f32 v35, v35
    v_exp_f32 v36, v36
    v_exp_f32 v37, v37
    v_cvt_pk_bf16_f32 v33, v34, v35
    v_exp_f32 v38, v38
    v_exp_f32 v39, v39
    v_mfma_f32_32x32x16_bf16 v[48:63], v[80:83], v[4:7], v[16:31]
    ds_read_b128 v[80:83], v2 offset:4096
    s_waitcnt lgkmcnt(2)
    v_cvt_pk_bf16_f32 v34, v36, v37
    v_exp_f32 v40, v40
    v_exp_f32 v41, v41
    v_cvt_pk_bf16_f32 v35, v38, v39
    v_exp_f32 v42, v42
    v_exp_f32 v43, v43
    v_cvt_pk_bf16_f32 v40, v40, v41
    v_exp_f32 v44, v44
    v_mfma_f32_32x32x16_bf16 v[64:79], v[84:87], v[32:35], v[64:79]
    ds_read_b128 v[84:87], v3 offset:3072
    s_waitcnt lgkmcnt(1)
    v_exp_f32 v45, v45
    v_cvt_pk_bf16_f32 v41, v42, v43
    v_exp_f32 v46, v46
    v_exp_f32 v47, v47
    v_cvt_pk_bf16_f32 v42, v44, v45
    v_cvt_pk_bf16_f32 v43, v46, v47
    v_exp_f32 v48, v48
    v_exp_f32 v49, v49
    v_exp_f32 v50, v50
    v_mfma_f32_32x32x16_bf16 v[64:79], v[88:91], v[40:43], v[64:79]
    ds_read_b128 v[88:91], v3 offset:3584
    s_add_u32 s19, s36, 16384
    buffer_load_dwordx4 v[220:223], v1, s[8:11], s19 offen offset:0
    v_cvt_pk_bf16_f32 v48, v48, v49
    v_exp_f32 v51, v51
    v_exp_f32 v52, v52
    v_exp_f32 v53, v53
    v_cvt_pk_bf16_f32 v49, v50, v51
    v_exp_f32 v54, v54
    v_exp_f32 v55, v55
    v_mfma_f32_32x32x16_bf16 v[32:47], v[80:83], v[4:7], v[16:31]
    ds_read_b128 v[80:83], v2 offset:5120
    s_waitcnt lgkmcnt(2)
    v_cvt_pk_bf16_f32 v50, v52, v53
    v_exp_f32 v56, v56
    v_exp_f32 v57, v57
    v_cvt_pk_bf16_f32 v51, v54, v55
    v_exp_f32 v58, v58
    v_exp_f32 v59, v59
    v_cvt_pk_bf16_f32 v56, v56, v57
    v_add_u32 v3, v3, v12
    v_exp_f32 v60, v60
    v_mfma_f32_32x32x16_bf16 v[64:79], v[84:87], v[48:51], v[64:79]
    ds_read_b128 v[84:87], v3 offset:0
    s_waitcnt lgkmcnt(1)
    v_exp_f32 v61, v61
    v_cvt_pk_bf16_f32 v57, v58, v59
    v_exp_f32 v62, v62
    v_add_u32 v2, 4096, v2
    v_exp_f32 v63, v63
    v_cvt_pk_bf16_f32 v58, v60, v61
    v_cvt_pk_bf16_f32 v59, v62, v63
    v_exp_f32 v32, v32
    v_exp_f32 v33, v33
    v_exp_f32 v34, v34
    v_mfma_f32_32x32x16_bf16 v[64:79], v[88:91], v[56:59], v[64:79]
    ds_read_b128 v[88:91], v3 offset:512
    s_add_u32 s19, s36, 16384
    buffer_load_dwordx4 v[224:227], v1, s[8:11], s19 offen offset:1024
    v_cvt_pk_bf16_f32 v32, v32, v33
    v_exp_f32 v35, v35
    v_exp_f32 v36, v36
    v_exp_f32 v37, v37
    v_cvt_pk_bf16_f32 v33, v34, v35
    v_exp_f32 v38, v38
    v_exp_f32 v39, v39
    v_mfma_f32_32x32x16_bf16 v[48:63], v[80:83], v[4:7], v[16:31]
    ds_read_b128 v[80:83], v2 offset:2048
    s_waitcnt lgkmcnt(2)
    v_cvt_pk_bf16_f32 v34, v36, v37
    v_exp_f32 v40, v40
    v_exp_f32 v41, v41
    v_cvt_pk_bf16_f32 v35, v38, v39
    v_exp_f32 v42, v42
    v_exp_f32 v43, v43
    v_cvt_pk_bf16_f32 v40, v40, v41
    v_exp_f32 v44, v44
    v_mfma_f32_32x32x16_bf16 v[64:79], v[84:87], v[32:35], v[64:79]
    ds_read_b128 v[84:87], v3 offset:1024
    s_waitcnt lgkmcnt(1)
    v_exp_f32 v45, v45
    v_cvt_pk_bf16_f32 v41, v42, v43
    v_exp_f32 v46, v46
    v_exp_f32 v47, v47
    v_cvt_pk_bf16_f32 v42, v44, v45
    v_cvt_pk_bf16_f32 v43, v46, v47
    v_exp_f32 v48, v48
    v_exp_f32 v49, v49
    v_exp_f32 v50, v50
    v_mfma_f32_32x32x16_bf16 v[64:79], v[88:91], v[40:43], v[64:79]
    ds_read_b128 v[88:91], v3 offset:1536
    s_add_u32 s19, s36, 16384
    buffer_load_dwordx4 v[228:231], v1, s[8:11], s19 offen offset:2048
    v_cvt_pk_bf16_f32 v48, v48, v49
    v_exp_f32 v51, v51
    v_exp_f32 v52, v52
    v_exp_f32 v53, v53
    v_cvt_pk_bf16_f32 v49, v50, v51
    v_exp_f32 v54, v54
    v_exp_f32 v55, v55
    v_mfma_f32_32x32x16_bf16 v[32:47], v[80:83], v[4:7], v[16:31]
    ds_read_b128 v[80:83], v2 offset:3072
    s_waitcnt lgkmcnt(2)
    v_cvt_pk_bf16_f32 v50, v52, v53
    v_exp_f32 v56, v56
    v_exp_f32 v57, v57
    v_cvt_pk_bf16_f32 v51, v54, v55
    v_exp_f32 v58, v58
    v_exp_f32 v59, v59
    v_cvt_pk_bf16_f32 v56, v56, v57
    v_exp_f32 v60, v60
    v_mfma_f32_32x32x16_bf16 v[64:79], v[84:87], v[48:51], v[64:79]
    ds_read_b128 v[84:87], v3 offset:2048
    s_waitcnt lgkmcnt(1)
    v_exp_f32 v61, v61
    v_cvt_pk_bf16_f32 v57, v58, v59
    v_exp_f32 v62, v62
    v_exp_f32 v63, v63
    v_cvt_pk_bf16_f32 v58, v60, v61
    v_cvt_pk_bf16_f32 v59, v62, v63
    v_exp_f32 v32, v32
    v_exp_f32 v33, v33
    v_exp_f32 v34, v34
    v_mfma_f32_32x32x16_bf16 v[64:79], v[88:91], v[56:59], v[64:79]
    ds_read_b128 v[88:91], v3 offset:2560
    s_add_u32 s19, s36, 16384
    buffer_load_dwordx4 v[232:235], v1, s[8:11], s19 offen offset:3072
    v_cvt_pk_bf16_f32 v32, v32, v33
    v_exp_f32 v35, v35
    v_exp_f32 v36, v36
    v_exp_f32 v37, v37
    v_cvt_pk_bf16_f32 v33, v34, v35
    v_exp_f32 v38, v38
    v_exp_f32 v39, v39
    v_mfma_f32_32x32x16_bf16 v[48:63], v[80:83], v[4:7], v[16:31]
    ds_read_b128 v[80:83], v2 offset:4096
    s_waitcnt lgkmcnt(2)
    v_cvt_pk_bf16_f32 v34, v36, v37
    v_exp_f32 v40, v40
    v_exp_f32 v41, v41
    v_cvt_pk_bf16_f32 v35, v38, v39
    v_exp_f32 v42, v42
    v_exp_f32 v43, v43
    v_cvt_pk_bf16_f32 v40, v40, v41
    v_exp_f32 v44, v44
    v_mfma_f32_32x32x16_bf16 v[64:79], v[84:87], v[32:35], v[64:79]
    ds_read_b128 v[84:87], v3 offset:3072
    s_waitcnt lgkmcnt(1)
    v_exp_f32 v45, v45
    v_cvt_pk_bf16_f32 v41, v42, v43
    v_exp_f32 v46, v46
    v_exp_f32 v47, v47
    v_cvt_pk_bf16_f32 v42, v44, v45
    v_cvt_pk_bf16_f32 v43, v46, v47
    v_exp_f32 v48, v48
    v_exp_f32 v49, v49
    v_exp_f32 v50, v50
    v_mfma_f32_32x32x16_bf16 v[64:79], v[88:91], v[40:43], v[64:79]
    ds_read_b128 v[88:91], v3 offset:3584
    s_add_u32 s19, s36, 20480
    buffer_load_dwordx4 v[236:239], v1, s[8:11], s19 offen offset:0
    v_cvt_pk_bf16_f32 v48, v48, v49
    v_exp_f32 v51, v51
    v_exp_f32 v52, v52
    v_exp_f32 v53, v53
    v_cvt_pk_bf16_f32 v49, v50, v51
    v_exp_f32 v54, v54
    v_exp_f32 v55, v55
    v_mfma_f32_32x32x16_bf16 v[32:47], v[80:83], v[4:7], v[16:31]
    ds_read_b128 v[80:83], v2 offset:5120
    s_waitcnt lgkmcnt(2)
    v_cvt_pk_bf16_f32 v50, v52, v53
    v_exp_f32 v56, v56
    v_exp_f32 v57, v57
    v_cvt_pk_bf16_f32 v51, v54, v55
    v_exp_f32 v58, v58
    v_exp_f32 v59, v59
    v_cvt_pk_bf16_f32 v56, v56, v57
    v_add_u32 v3, v3, v12
    v_exp_f32 v60, v60
    v_mfma_f32_32x32x16_bf16 v[64:79], v[84:87], v[48:51], v[64:79]
    ds_read_b128 v[84:87], v3 offset:0
    s_waitcnt lgkmcnt(1)
    v_exp_f32 v61, v61
    v_cvt_pk_bf16_f32 v57, v58, v59
    v_exp_f32 v62, v62
    v_add_u32 v2, 4096, v2
    v_exp_f32 v63, v63
    v_cvt_pk_bf16_f32 v58, v60, v61
    v_cvt_pk_bf16_f32 v59, v62, v63
    v_exp_f32 v32, v32
    v_exp_f32 v33, v33
    v_exp_f32 v34, v34
    v_mfma_f32_32x32x16_bf16 v[64:79], v[88:91], v[56:59], v[64:79]
    ds_read_b128 v[88:91], v3 offset:512
    s_add_u32 s19, s36, 20480
    buffer_load_dwordx4 v[240:243], v1, s[8:11], s19 offen offset:1024
    v_cvt_pk_bf16_f32 v32, v32, v33
    v_exp_f32 v35, v35
    v_exp_f32 v36, v36
    v_exp_f32 v37, v37
    v_cvt_pk_bf16_f32 v33, v34, v35
    v_exp_f32 v38, v38
    v_exp_f32 v39, v39
    v_mfma_f32_32x32x16_bf16 v[48:63], v[80:83], v[4:7], v[16:31]
    ds_read_b128 v[80:83], v2 offset:2048
    s_waitcnt lgkmcnt(2)
    v_cvt_pk_bf16_f32 v34, v36, v37
    v_exp_f32 v40, v40
    v_exp_f32 v41, v41
    v_cvt_pk_bf16_f32 v35, v38, v39
    v_exp_f32 v42, v42
    v_exp_f32 v43, v43
    v_cvt_pk_bf16_f32 v40, v40, v41
    v_exp_f32 v44, v44
    v_mfma_f32_32x32x16_bf16 v[64:79], v[84:87], v[32:35], v[64:79]
    ds_read_b128 v[84:87], v3 offset:1024
    s_waitcnt lgkmcnt(1)
    v_exp_f32 v45, v45
    v_cvt_pk_bf16_f32 v41, v42, v43
    v_exp_f32 v46, v46
    v_exp_f32 v47, v47
    v_cvt_pk_bf16_f32 v42, v44, v45
    v_cvt_pk_bf16_f32 v43, v46, v47
    v_exp_f32 v48, v48
    v_exp_f32 v49, v49
    v_exp_f32 v50, v50
    v_mfma_f32_32x32x16_bf16 v[64:79], v[88:91], v[40:43], v[64:79]
    ds_read_b128 v[88:91], v3 offset:1536
    s_add_u32 s19, s36, 20480
    buffer_load_dwordx4 v[244:247], v1, s[8:11], s19 offen offset:2048
    v_cvt_pk_bf16_f32 v48, v48, v49
    v_exp_f32 v51, v51
    v_exp_f32 v52, v52
    v_exp_f32 v53, v53
    v_cvt_pk_bf16_f32 v49, v50, v51
    v_exp_f32 v54, v54
    v_exp_f32 v55, v55
    v_mfma_f32_32x32x16_bf16 v[32:47], v[80:83], v[4:7], v[16:31]
    ds_read_b128 v[80:83], v2 offset:3072
    s_waitcnt lgkmcnt(2)
    v_cvt_pk_bf16_f32 v50, v52, v53
    v_exp_f32 v56, v56
    v_exp_f32 v57, v57
    v_cvt_pk_bf16_f32 v51, v54, v55
    v_exp_f32 v58, v58
    v_exp_f32 v59, v59
    v_cvt_pk_bf16_f32 v56, v56, v57
    v_exp_f32 v60, v60
    v_mfma_f32_32x32x16_bf16 v[64:79], v[84:87], v[48:51], v[64:79]
    ds_read_b128 v[84:87], v3 offset:2048
    s_waitcnt lgkmcnt(1)
    v_exp_f32 v61, v61
    v_cvt_pk_bf16_f32 v57, v58, v59
    v_exp_f32 v62, v62
    v_exp_f32 v63, v63
    v_cvt_pk_bf16_f32 v58, v60, v61
    v_cvt_pk_bf16_f32 v59, v62, v63
    v_exp_f32 v32, v32
    v_exp_f32 v33, v33
    v_exp_f32 v34, v34
    v_mfma_f32_32x32x16_bf16 v[64:79], v[88:91], v[56:59], v[64:79]
    ds_read_b128 v[88:91], v3 offset:2560
    s_add_u32 s19, s36, 20480
    buffer_load_dwordx4 v[248:251], v1, s[8:11], s19 offen offset:3072
    v_cvt_pk_bf16_f32 v32, v32, v33
    v_exp_f32 v35, v35
    v_exp_f32 v36, v36
    v_exp_f32 v37, v37
    v_cvt_pk_bf16_f32 v33, v34, v35
    v_exp_f32 v38, v38
    v_exp_f32 v39, v39
    v_mfma_f32_32x32x16_bf16 v[48:63], v[80:83], v[4:7], v[16:31]
    ds_read_b128 v[80:83], v2 offset:4096
    s_waitcnt lgkmcnt(2)
    v_cvt_pk_bf16_f32 v34, v36, v37
    v_exp_f32 v40, v40
    v_exp_f32 v41, v41
    v_cvt_pk_bf16_f32 v35, v38, v39
    v_exp_f32 v42, v42
    v_exp_f32 v43, v43
    v_cvt_pk_bf16_f32 v40, v40, v41
    v_exp_f32 v44, v44
    v_mfma_f32_32x32x16_bf16 v[64:79], v[84:87], v[32:35], v[64:79]
    ds_read_b128 v[84:87], v3 offset:3072
    s_waitcnt lgkmcnt(1)
    v_exp_f32 v45, v45
    v_cvt_pk_bf16_f32 v41, v42, v43
    v_exp_f32 v46, v46
    v_exp_f32 v47, v47
    v_cvt_pk_bf16_f32 v42, v44, v45
    v_cvt_pk_bf16_f32 v43, v46, v47
    v_exp_f32 v48, v48
    v_exp_f32 v49, v49
    v_exp_f32 v50, v50
    v_mfma_f32_32x32x16_bf16 v[64:79], v[88:91], v[40:43], v[64:79]
    ds_read_b128 v[88:91], v3 offset:3584
    buffer_load_dwordx4 v[124:127], v1, s[8:11], s54 offen offset:0
    v_cvt_pk_bf16_f32 v48, v48, v49
    v_exp_f32 v51, v51
    v_exp_f32 v52, v52
    v_exp_f32 v53, v53
    v_cvt_pk_bf16_f32 v49, v50, v51
    v_exp_f32 v54, v54
    v_exp_f32 v55, v55
    v_mfma_f32_32x32x16_bf16 v[32:47], v[80:83], v[4:7], v[16:31]
    ds_read_b128 v[80:83], v2 offset:5120
    s_waitcnt lgkmcnt(2)
    v_cvt_pk_bf16_f32 v50, v52, v53
    v_exp_f32 v56, v56
    v_exp_f32 v57, v57
    v_cvt_pk_bf16_f32 v51, v54, v55
    v_exp_f32 v58, v58
    v_exp_f32 v59, v59
    v_cvt_pk_bf16_f32 v56, v56, v57
    v_add_u32 v3, v3, v12
    v_exp_f32 v60, v60
    v_mfma_f32_32x32x16_bf16 v[64:79], v[84:87], v[48:51], v[64:79]
    ds_read_b128 v[84:87], v3 offset:0
    s_waitcnt lgkmcnt(1)
    v_exp_f32 v61, v61
    v_cvt_pk_bf16_f32 v57, v58, v59
    v_exp_f32 v62, v62
    v_add_u32 v2, 4096, v2
    v_exp_f32 v63, v63
    v_cvt_pk_bf16_f32 v58, v60, v61
    v_cvt_pk_bf16_f32 v59, v62, v63
    v_exp_f32 v32, v32
    v_exp_f32 v33, v33
    v_exp_f32 v34, v34
    v_mfma_f32_32x32x16_bf16 v[64:79], v[88:91], v[56:59], v[64:79]
    ds_read_b128 v[88:91], v3 offset:512
    buffer_load_dwordx4 v[128:131], v1, s[8:11], s54 offen offset:1024
    v_cvt_pk_bf16_f32 v32, v32, v33
    v_exp_f32 v35, v35
    v_exp_f32 v36, v36
    v_exp_f32 v37, v37
    v_cvt_pk_bf16_f32 v33, v34, v35
    v_exp_f32 v38, v38
    v_exp_f32 v39, v39
    v_mfma_f32_32x32x16_bf16 v[48:63], v[80:83], v[4:7], v[16:31]
    ds_read_b128 v[80:83], v2 offset:2048
    s_waitcnt lgkmcnt(2)
    v_cvt_pk_bf16_f32 v34, v36, v37
    v_exp_f32 v40, v40
    v_exp_f32 v41, v41
    v_cvt_pk_bf16_f32 v35, v38, v39
    v_exp_f32 v42, v42
    v_exp_f32 v43, v43
    v_cvt_pk_bf16_f32 v40, v40, v41
    v_exp_f32 v44, v44
    v_mfma_f32_32x32x16_bf16 v[64:79], v[84:87], v[32:35], v[64:79]
    ds_read_b128 v[84:87], v3 offset:1024
    s_waitcnt lgkmcnt(1)
    v_exp_f32 v45, v45
    v_cvt_pk_bf16_f32 v41, v42, v43
    v_exp_f32 v46, v46
    v_exp_f32 v47, v47
    v_cvt_pk_bf16_f32 v42, v44, v45
    v_cvt_pk_bf16_f32 v43, v46, v47
    v_exp_f32 v48, v48
    v_exp_f32 v49, v49
    v_exp_f32 v50, v50
    v_mfma_f32_32x32x16_bf16 v[64:79], v[88:91], v[40:43], v[64:79]
    ds_read_b128 v[88:91], v3 offset:1536
    buffer_load_dwordx4 v[132:135], v1, s[8:11], s54 offen offset:2048
    v_cvt_pk_bf16_f32 v48, v48, v49
    v_exp_f32 v51, v51
    v_exp_f32 v52, v52
    v_exp_f32 v53, v53
    v_cvt_pk_bf16_f32 v49, v50, v51
    v_exp_f32 v54, v54
    v_exp_f32 v55, v55
    v_mfma_f32_32x32x16_bf16 v[32:47], v[80:83], v[4:7], v[16:31]
    ds_read_b128 v[80:83], v2 offset:3072
    s_waitcnt lgkmcnt(2)
    v_cvt_pk_bf16_f32 v50, v52, v53
    v_exp_f32 v56, v56
    v_exp_f32 v57, v57
    v_cvt_pk_bf16_f32 v51, v54, v55
    v_exp_f32 v58, v58
    v_exp_f32 v59, v59
    v_cvt_pk_bf16_f32 v56, v56, v57
    v_exp_f32 v60, v60
    v_mfma_f32_32x32x16_bf16 v[64:79], v[84:87], v[48:51], v[64:79]
    ds_read_b128 v[84:87], v3 offset:2048
    s_waitcnt lgkmcnt(1)
    buffer_load_dword v8, v9, s[8:11], s58 offen sc1
    v_exp_f32 v61, v61
    v_cvt_pk_bf16_f32 v57, v58, v59
    v_exp_f32 v62, v62
    v_exp_f32 v63, v63
    v_cvt_pk_bf16_f32 v58, v60, v61
    v_cvt_pk_bf16_f32 v59, v62, v63
    s_setprio 2
    v_exp_f32 v32, v32
    v_exp_f32 v33, v33
    v_exp_f32 v34, v34
    v_mfma_f32_32x32x16_bf16 v[64:79], v[88:91], v[56:59], v[64:79]
    ds_read_b128 v[88:91], v3 offset:2560
    buffer_load_dwordx4 v[136:139], v1, s[8:11], s54 offen offset:3072
    v_cvt_pk_bf16_f32 v32, v32, v33
    v_exp_f32 v35, v35
    v_exp_f32 v36, v36
    v_exp_f32 v37, v37
    v_cvt_pk_bf16_f32 v33, v34, v35
    v_exp_f32 v38, v38
    v_exp_f32 v39, v39
    v_mfma_f32_32x32x16_bf16 v[48:63], v[80:83], v[4:7], v[16:31]
    ds_read_b128 v[80:83], v2 offset:4096
    s_waitcnt lgkmcnt(2)
    v_cvt_pk_bf16_f32 v34, v36, v37
    v_exp_f32 v40, v40
    v_exp_f32 v41, v41
    v_cvt_pk_bf16_f32 v35, v38, v39
    v_exp_f32 v42, v42
    v_exp_f32 v43, v43
    v_cvt_pk_bf16_f32 v40, v40, v41
    v_exp_f32 v44, v44
    v_mfma_f32_32x32x16_bf16 v[64:79], v[84:87], v[32:35], v[64:79]
    ds_read_b128 v[84:87], v3 offset:3072
    s_waitcnt lgkmcnt(1)
    v_exp_f32 v45, v45
    v_cvt_pk_bf16_f32 v41, v42, v43
    v_exp_f32 v46, v46
    v_exp_f32 v47, v47
    v_cvt_pk_bf16_f32 v42, v44, v45
    v_cvt_pk_bf16_f32 v43, v46, v47
    v_exp_f32 v48, v48
    v_exp_f32 v49, v49
    v_exp_f32 v50, v50
    v_mfma_f32_32x32x16_bf16 v[64:79], v[88:91], v[40:43], v[64:79]
    ds_read_b128 v[88:91], v3 offset:3584
    s_add_u32 s19, s54, 4096
    buffer_load_dwordx4 v[140:143], v1, s[8:11], s19 offen offset:0
    v_cvt_pk_bf16_f32 v48, v48, v49
    v_exp_f32 v51, v51
    v_exp_f32 v52, v52
    v_exp_f32 v53, v53
    v_cvt_pk_bf16_f32 v49, v50, v51
    v_exp_f32 v54, v54
    v_exp_f32 v55, v55
    v_mfma_f32_32x32x16_bf16 v[32:47], v[80:83], v[4:7], v[16:31]
    ds_read_b128 v[80:83], v2 offset:5120
    s_waitcnt lgkmcnt(2)
    v_cvt_pk_bf16_f32 v50, v52, v53
    v_exp_f32 v56, v56
    v_exp_f32 v57, v57
    v_cvt_pk_bf16_f32 v51, v54, v55
    v_exp_f32 v58, v58
    v_exp_f32 v59, v59
    v_cvt_pk_bf16_f32 v56, v56, v57
    v_add_u32 v3, v3, v12
    v_exp_f32 v60, v60
    v_mfma_f32_32x32x16_bf16 v[64:79], v[84:87], v[48:51], v[64:79]
    ds_read_b128 v[84:87], v3 offset:0
    s_waitcnt lgkmcnt(1)
    s_add_u32 s19, s58, 229376
    buffer_load_dword v8, v9, s[8:11], s19 offen sc1
    v_exp_f32 v61, v61
    v_cvt_pk_bf16_f32 v57, v58, v59
    v_exp_f32 v62, v62
    v_add_u32 v2, 4096, v2
    v_exp_f32 v63, v63
    v_cvt_pk_bf16_f32 v58, v60, v61
    v_cvt_pk_bf16_f32 v59, v62, v63
    v_exp_f32 v32, v32
    v_exp_f32 v33, v33
    v_exp_f32 v34, v34
    v_mfma_f32_32x32x16_bf16 v[64:79], v[88:91], v[56:59], v[64:79]
    ds_read_b128 v[88:91], v3 offset:512
    s_add_u32 s19, s54, 4096
    buffer_load_dwordx4 v[144:147], v1, s[8:11], s19 offen offset:1024
    v_cvt_pk_bf16_f32 v32, v32, v33
    v_exp_f32 v35, v35
    v_exp_f32 v36, v36
    v_exp_f32 v37, v37
    v_cvt_pk_bf16_f32 v33, v34, v35
    v_exp_f32 v38, v38
    v_exp_f32 v39, v39
    v_mfma_f32_32x32x16_bf16 v[48:63], v[80:83], v[4:7], v[16:31]
    ds_read_b128 v[80:83], v2 offset:2048
    s_waitcnt lgkmcnt(2)
    v_cvt_pk_bf16_f32 v34, v36, v37
    v_exp_f32 v40, v40
    v_exp_f32 v41, v41
    v_cvt_pk_bf16_f32 v35, v38, v39
    v_exp_f32 v42, v42
    v_exp_f32 v43, v43
    v_cvt_pk_bf16_f32 v40, v40, v41
    v_exp_f32 v44, v44
    v_mfma_f32_32x32x16_bf16 v[64:79], v[84:87], v[32:35], v[64:79]
    ds_read_b128 v[84:87], v3 offset:1024
    s_waitcnt lgkmcnt(1)
    v_exp_f32 v45, v45
    v_cvt_pk_bf16_f32 v41, v42, v43
    v_exp_f32 v46, v46
    v_exp_f32 v47, v47
    v_cvt_pk_bf16_f32 v42, v44, v45
    v_cvt_pk_bf16_f32 v43, v46, v47
    v_exp_f32 v48, v48
    v_exp_f32 v49, v49
    v_exp_f32 v50, v50
    v_mfma_f32_32x32x16_bf16 v[64:79], v[88:91], v[40:43], v[64:79]
    ds_read_b128 v[88:91], v3 offset:1536
    s_add_u32 s19, s54, 4096
    buffer_load_dwordx4 v[148:151], v1, s[8:11], s19 offen offset:2048
    v_cvt_pk_bf16_f32 v48, v48, v49
    v_exp_f32 v51, v51
    v_exp_f32 v52, v52
    v_exp_f32 v53, v53
    v_cvt_pk_bf16_f32 v49, v50, v51
    v_exp_f32 v54, v54
    v_exp_f32 v55, v55
    v_mfma_f32_32x32x16_bf16 v[32:47], v[80:83], v[4:7], v[16:31]
    ds_read_b128 v[80:83], v2 offset:3072
    s_waitcnt lgkmcnt(2)
    v_cvt_pk_bf16_f32 v50, v52, v53
    v_exp_f32 v56, v56
    v_exp_f32 v57, v57
    v_cvt_pk_bf16_f32 v51, v54, v55
    v_exp_f32 v58, v58
    v_exp_f32 v59, v59
    v_cvt_pk_bf16_f32 v56, v56, v57
    v_exp_f32 v60, v60
    v_mfma_f32_32x32x16_bf16 v[64:79], v[84:87], v[48:51], v[64:79]
    ds_read_b128 v[84:87], v3 offset:2048
    s_waitcnt lgkmcnt(1)
    buffer_load_dword v8, v1, s[8:11], s21 offen sc1
    v_exp_f32 v61, v61
    v_cvt_pk_bf16_f32 v57, v58, v59
    v_exp_f32 v62, v62
    v_exp_f32 v63, v63
    v_cvt_pk_bf16_f32 v58, v60, v61
    v_cvt_pk_bf16_f32 v59, v62, v63
    v_exp_f32 v32, v32
    v_exp_f32 v33, v33
    v_exp_f32 v34, v34
    v_mfma_f32_32x32x16_bf16 v[64:79], v[88:91], v[56:59], v[64:79]
    ds_read_b128 v[88:91], v3 offset:2560
    s_add_u32 s19, s54, 4096
    buffer_load_dwordx4 v[152:155], v1, s[8:11], s19 offen offset:3072
    v_cvt_pk_bf16_f32 v32, v32, v33
    v_exp_f32 v35, v35
    v_exp_f32 v36, v36
    v_exp_f32 v37, v37
    v_cvt_pk_bf16_f32 v33, v34, v35
    v_exp_f32 v38, v38
    v_exp_f32 v39, v39
    v_mfma_f32_32x32x16_bf16 v[48:63], v[80:83], v[4:7], v[16:31]
    ds_read_b128 v[80:83], v2 offset:4096
    s_waitcnt lgkmcnt(2)
    v_cvt_pk_bf16_f32 v34, v36, v37
    v_exp_f32 v40, v40
    v_exp_f32 v41, v41
    v_cvt_pk_bf16_f32 v35, v38, v39
    v_exp_f32 v42, v42
    v_exp_f32 v43, v43
    v_cvt_pk_bf16_f32 v40, v40, v41
    v_exp_f32 v44, v44
    v_mfma_f32_32x32x16_bf16 v[64:79], v[84:87], v[32:35], v[64:79]
    ds_read_b128 v[84:87], v3 offset:3072
    s_waitcnt lgkmcnt(1)
    v_exp_f32 v45, v45
    v_cvt_pk_bf16_f32 v41, v42, v43
    v_exp_f32 v46, v46
    v_exp_f32 v47, v47
    v_cvt_pk_bf16_f32 v42, v44, v45
    v_cvt_pk_bf16_f32 v43, v46, v47
    v_exp_f32 v48, v48
    v_exp_f32 v49, v49
    v_exp_f32 v50, v50
    v_mfma_f32_32x32x16_bf16 v[64:79], v[88:91], v[40:43], v[64:79]
    ds_read_b128 v[88:91], v3 offset:3584
    buffer_load_dwordx4 v[92:95], v1, s[8:11], s38 offen offset:0
    v_cvt_pk_bf16_f32 v48, v48, v49
    v_exp_f32 v51, v51
    v_exp_f32 v52, v52
    v_exp_f32 v53, v53
    v_cvt_pk_bf16_f32 v49, v50, v51
    v_exp_f32 v54, v54
    v_exp_f32 v55, v55
    v_mfma_f32_32x32x16_bf16 v[32:47], v[80:83], v[4:7], v[16:31]
    ds_read_b128 v[80:83], v2 offset:5120
    s_waitcnt lgkmcnt(2)
    v_cvt_pk_bf16_f32 v50, v52, v53
    v_exp_f32 v56, v56
    v_exp_f32 v57, v57
    v_cvt_pk_bf16_f32 v51, v54, v55
    v_exp_f32 v58, v58
    v_exp_f32 v59, v59
    v_cvt_pk_bf16_f32 v56, v56, v57
    v_add_u32 v3, v3, v12
    v_exp_f32 v60, v60
    v_mfma_f32_32x32x16_bf16 v[64:79], v[84:87], v[48:51], v[64:79]
    ds_read_b128 v[84:87], v3 offset:0
    s_waitcnt lgkmcnt(1)
    s_add_u32 s19, s21, 4194304
    buffer_load_dword v8, v1, s[8:11], s19 offen sc1
    v_exp_f32 v61, v61
    v_cvt_pk_bf16_f32 v57, v58, v59
    v_exp_f32 v62, v62
    v_add_u32 v2, 4096, v2
    v_exp_f32 v63, v63
    v_cvt_pk_bf16_f32 v58, v60, v61
    v_cvt_pk_bf16_f32 v59, v62, v63
    v_exp_f32 v32, v32
    v_exp_f32 v33, v33
    v_exp_f32 v34, v34
    v_mfma_f32_32x32x16_bf16 v[64:79], v[88:91], v[56:59], v[64:79]
    ds_read_b128 v[88:91], v3 offset:512
    buffer_load_dwordx4 v[96:99], v1, s[8:11], s38 offen offset:1024
    v_cvt_pk_bf16_f32 v32, v32, v33
    v_exp_f32 v35, v35
    v_exp_f32 v36, v36
    v_exp_f32 v37, v37
    v_cvt_pk_bf16_f32 v33, v34, v35
    v_exp_f32 v38, v38
    v_exp_f32 v39, v39
    v_mfma_f32_32x32x16_bf16 v[48:63], v[80:83], v[4:7], v[16:31]
    ds_read_b128 v[80:83], v2 offset:2048
    s_waitcnt lgkmcnt(2)
    v_cvt_pk_bf16_f32 v34, v36, v37
    v_exp_f32 v40, v40
    v_exp_f32 v41, v41
    v_cvt_pk_bf16_f32 v35, v38, v39
    v_exp_f32 v42, v42
    v_exp_f32 v43, v43
    v_cvt_pk_bf16_f32 v40, v40, v41
    v_exp_f32 v44, v44
    v_mfma_f32_32x32x16_bf16 v[64:79], v[84:87], v[32:35], v[64:79]
    ds_read_b128 v[84:87], v3 offset:1024
    s_waitcnt lgkmcnt(1)
    v_exp_f32 v45, v45
    v_cvt_pk_bf16_f32 v41, v42, v43
    v_exp_f32 v46, v46
    v_exp_f32 v47, v47
    v_cvt_pk_bf16_f32 v42, v44, v45
    v_cvt_pk_bf16_f32 v43, v46, v47
    v_exp_f32 v48, v48
    v_exp_f32 v49, v49
    v_exp_f32 v50, v50
    v_mfma_f32_32x32x16_bf16 v[64:79], v[88:91], v[40:43], v[64:79]
    ds_read_b128 v[88:91], v3 offset:1536
    buffer_load_dwordx4 v[100:103], v1, s[8:11], s38 offen offset:2048
    v_cvt_pk_bf16_f32 v48, v48, v49
    v_exp_f32 v51, v51
    v_exp_f32 v52, v52
    v_exp_f32 v53, v53
    v_cvt_pk_bf16_f32 v49, v50, v51
    v_exp_f32 v54, v54
    v_exp_f32 v55, v55
    v_mfma_f32_32x32x16_bf16 v[32:47], v[80:83], v[4:7], v[16:31]
    ds_read_b128 v[80:83], v2 offset:3072
    s_waitcnt lgkmcnt(2)
    v_cvt_pk_bf16_f32 v50, v52, v53
    v_exp_f32 v56, v56
    v_exp_f32 v57, v57
    v_cvt_pk_bf16_f32 v51, v54, v55
    v_exp_f32 v58, v58
    v_exp_f32 v59, v59
    v_cvt_pk_bf16_f32 v56, v56, v57
    v_exp_f32 v60, v60
    v_mfma_f32_32x32x16_bf16 v[64:79], v[84:87], v[48:51], v[64:79]
    ds_read_b128 v[84:87], v3 offset:2048
    s_waitcnt lgkmcnt(1)
    s_lshr_b32 s19, s61, 2
    s_add_u32 s19, s19, s35
    s_add_u32 s19, s19, 6291456
    buffer_load_dword v8, v11, s[8:11], s19 offen sc1
    v_exp_f32 v61, v61
    v_cvt_pk_bf16_f32 v57, v58, v59
    v_exp_f32 v62, v62
    v_exp_f32 v63, v63
    v_cvt_pk_bf16_f32 v58, v60, v61
    v_cvt_pk_bf16_f32 v59, v62, v63
    v_exp_f32 v32, v32
    v_exp_f32 v33, v33
    v_exp_f32 v34, v34
    v_mfma_f32_32x32x16_bf16 v[64:79], v[88:91], v[56:59], v[64:79]
    ds_read_b128 v[88:91], v3 offset:2560
    buffer_load_dwordx4 v[104:107], v1, s[8:11], s38 offen offset:3072
    v_cvt_pk_bf16_f32 v32, v32, v33
    v_exp_f32 v35, v35
    v_exp_f32 v36, v36
    v_exp_f32 v37, v37
    v_cvt_pk_bf16_f32 v33, v34, v35
    v_exp_f32 v38, v38
    v_exp_f32 v39, v39
    v_mfma_f32_32x32x16_bf16 v[48:63], v[80:83], v[4:7], v[16:31]
    ds_read_b128 v[80:83], v2 offset:4096
    s_waitcnt lgkmcnt(2)
    v_cvt_pk_bf16_f32 v34, v36, v37
    v_exp_f32 v40, v40
    v_exp_f32 v41, v41
    v_cvt_pk_bf16_f32 v35, v38, v39
    v_exp_f32 v42, v42
    v_exp_f32 v43, v43
    v_cvt_pk_bf16_f32 v40, v40, v41
    v_exp_f32 v44, v44
    v_mfma_f32_32x32x16_bf16 v[64:79], v[84:87], v[32:35], v[64:79]
    ds_read_b128 v[84:87], v3 offset:3072
    s_waitcnt lgkmcnt(1)
    v_exp_f32 v45, v45
    v_cvt_pk_bf16_f32 v41, v42, v43
    v_exp_f32 v46, v46
    v_exp_f32 v47, v47
    v_cvt_pk_bf16_f32 v42, v44, v45
    v_cvt_pk_bf16_f32 v43, v46, v47
    v_exp_f32 v48, v48
    v_exp_f32 v49, v49
    v_exp_f32 v50, v50
    v_mfma_f32_32x32x16_bf16 v[64:79], v[88:91], v[40:43], v[64:79]
    ds_read_b128 v[88:91], v3 offset:3584
    s_add_u32 s19, s38, 4096
    buffer_load_dwordx4 v[108:111], v1, s[8:11], s19 offen offset:0
    v_cvt_pk_bf16_f32 v48, v48, v49
    v_exp_f32 v51, v51
    v_exp_f32 v52, v52
    v_exp_f32 v53, v53
    v_cvt_pk_bf16_f32 v49, v50, v51
    v_exp_f32 v54, v54
    v_exp_f32 v55, v55
    v_mfma_f32_32x32x16_bf16 v[32:47], v[80:83], v[4:7], v[16:31]
    ds_read_b128 v[80:83], v2 offset:5120
    s_waitcnt lgkmcnt(2)
    v_cvt_pk_bf16_f32 v50, v52, v53
    v_exp_f32 v56, v56
    v_exp_f32 v57, v57
    v_cvt_pk_bf16_f32 v51, v54, v55
    v_exp_f32 v58, v58
    v_exp_f32 v59, v59
    v_cvt_pk_bf16_f32 v56, v56, v57
    v_add_u32 v3, v3, v12
    v_exp_f32 v60, v60
    v_mfma_f32_32x32x16_bf16 v[64:79], v[84:87], v[48:51], v[64:79]
    ds_read_b128 v[84:87], v3 offset:0
    s_waitcnt lgkmcnt(1)
    v_exp_f32 v61, v61
    v_cvt_pk_bf16_f32 v57, v58, v59
    v_exp_f32 v62, v62
    v_add_u32 v2, 4096, v2
    v_exp_f32 v63, v63
    v_cvt_pk_bf16_f32 v58, v60, v61
    v_cvt_pk_bf16_f32 v59, v62, v63
    v_exp_f32 v32, v32
    v_exp_f32 v33, v33
    v_exp_f32 v34, v34
    v_mfma_f32_32x32x16_bf16 v[64:79], v[88:91], v[56:59], v[64:79]
    ds_read_b128 v[88:91], v3 offset:512
    s_add_u32 s19, s38, 4096
    buffer_load_dwordx4 v[112:115], v1, s[8:11], s19 offen offset:1024
    v_cvt_pk_bf16_f32 v32, v32, v33
    v_exp_f32 v35, v35
    v_exp_f32 v36, v36
    v_exp_f32 v37, v37
    v_cvt_pk_bf16_f32 v33, v34, v35
    v_exp_f32 v38, v38
    v_exp_f32 v39, v39
    v_mfma_f32_32x32x16_bf16 v[48:63], v[80:83], v[4:7], v[16:31]
    ds_read_b128 v[80:83], v2 offset:2048
    s_waitcnt lgkmcnt(2)
    v_cvt_pk_bf16_f32 v34, v36, v37
    v_exp_f32 v40, v40
    v_exp_f32 v41, v41
    v_cvt_pk_bf16_f32 v35, v38, v39
    v_exp_f32 v42, v42
    v_exp_f32 v43, v43
    v_cvt_pk_bf16_f32 v40, v40, v41
    v_exp_f32 v44, v44
    v_mfma_f32_32x32x16_bf16 v[64:79], v[84:87], v[32:35], v[64:79]
    ds_read_b128 v[84:87], v3 offset:1024
    s_waitcnt lgkmcnt(1)
    v_exp_f32 v45, v45
    v_cvt_pk_bf16_f32 v41, v42, v43
    v_exp_f32 v46, v46
    v_exp_f32 v47, v47
    v_cvt_pk_bf16_f32 v42, v44, v45
    v_cvt_pk_bf16_f32 v43, v46, v47
    s_setprio 1
    v_exp_f32 v48, v48
    v_exp_f32 v49, v49
    v_exp_f32 v50, v50
    v_mfma_f32_32x32x16_bf16 v[64:79], v[88:91], v[40:43], v[64:79]
    ds_read_b128 v[88:91], v3 offset:1536
    s_add_u32 s19, s38, 4096
    buffer_load_dwordx4 v[116:119], v1, s[8:11], s19 offen offset:2048
    v_cvt_pk_bf16_f32 v48, v48, v49
    v_exp_f32 v51, v51
    v_exp_f32 v52, v52
    v_exp_f32 v53, v53
    v_cvt_pk_bf16_f32 v49, v50, v51
    v_exp_f32 v54, v54
    v_exp_f32 v55, v55
    v_mfma_f32_32x32x16_bf16 v[32:47], v[80:83], v[4:7], v[16:31]
    ds_read_b128 v[80:83], v2 offset:3072
    s_waitcnt lgkmcnt(2)
    v_cvt_pk_bf16_f32 v50, v52, v53
    v_exp_f32 v56, v56
    v_exp_f32 v57, v57
    v_cvt_pk_bf16_f32 v51, v54, v55
    v_exp_f32 v58, v58
    v_exp_f32 v59, v59
    v_cvt_pk_bf16_f32 v56, v56, v57
    v_exp_f32 v60, v60
    v_mfma_f32_32x32x16_bf16 v[64:79], v[84:87], v[48:51], v[64:79]
    ds_read_b128 v[84:87], v3 offset:2048
    s_waitcnt lgkmcnt(1)
    v_exp_f32 v61, v61
    v_cvt_pk_bf16_f32 v57, v58, v59
    v_exp_f32 v62, v62
    v_exp_f32 v63, v63
    v_cvt_pk_bf16_f32 v58, v60, v61
    v_cvt_pk_bf16_f32 v59, v62, v63
    v_exp_f32 v32, v32
    v_exp_f32 v33, v33
    v_exp_f32 v34, v34
    v_mfma_f32_32x32x16_bf16 v[64:79], v[88:91], v[56:59], v[64:79]
    ds_read_b128 v[88:91], v3 offset:2560
    s_add_u32 s19, s38, 4096
    buffer_load_dwordx4 v[120:123], v1, s[8:11], s19 offen offset:3072
    v_cvt_pk_bf16_f32 v32, v32, v33
    v_exp_f32 v35, v35
    v_exp_f32 v36, v36
    v_exp_f32 v37, v37
    v_cvt_pk_bf16_f32 v33, v34, v35
    v_exp_f32 v38, v38
    v_exp_f32 v39, v39
    v_mfma_f32_32x32x16_bf16 v[48:63], v[80:83], v[4:7], v[16:31]
    ds_read_b128 v[80:83], v2 offset:4096
    s_waitcnt lgkmcnt(2)
    v_cvt_pk_bf16_f32 v34, v36, v37
    v_exp_f32 v40, v40
    v_exp_f32 v41, v41
    v_cvt_pk_bf16_f32 v35, v38, v39
    v_exp_f32 v42, v42
    v_exp_f32 v43, v43
    v_cvt_pk_bf16_f32 v40, v40, v41
    v_exp_f32 v44, v44
    v_mfma_f32_32x32x16_bf16 v[64:79], v[84:87], v[32:35], v[64:79]
    ds_read_b128 v[84:87], v3 offset:3072
    s_waitcnt lgkmcnt(1)
    v_exp_f32 v45, v45
    v_cvt_pk_bf16_f32 v41, v42, v43
    v_exp_f32 v46, v46
    v_exp_f32 v47, v47
    v_cvt_pk_bf16_f32 v42, v44, v45
    v_cvt_pk_bf16_f32 v43, v46, v47
    v_exp_f32 v48, v48
    v_exp_f32 v49, v49
    v_exp_f32 v50, v50
    v_mfma_f32_32x32x16_bf16 v[64:79], v[88:91], v[40:43], v[64:79]
    ds_read_b128 v[88:91], v3 offset:3584
    v_cvt_pk_bf16_f32 v48, v48, v49
    v_exp_f32 v51, v51
    v_exp_f32 v52, v52
    v_exp_f32 v53, v53
    v_cvt_pk_bf16_f32 v49, v50, v51
    v_exp_f32 v54, v54
    v_exp_f32 v55, v55
    v_mfma_f32_32x32x16_bf16 v[32:47], v[80:83], v[4:7], v[16:31]
    ds_read_b128 v[80:83], v2 offset:5120
    s_waitcnt lgkmcnt(2)
    v_cvt_pk_bf16_f32 v50, v52, v53
    v_exp_f32 v56, v56
    v_exp_f32 v57, v57
    v_cvt_pk_bf16_f32 v51, v54, v55
    v_exp_f32 v58, v58
    v_exp_f32 v59, v59
    v_cvt_pk_bf16_f32 v56, v56, v57
    v_add_u32 v3, v3, v12
    v_exp_f32 v60, v60
    v_mfma_f32_32x32x16_bf16 v[64:79], v[84:87], v[48:51], v[64:79]
    ds_read_b128 v[84:87], v3 offset:0
    s_waitcnt lgkmcnt(1)
    v_exp_f32 v61, v61
    v_cvt_pk_bf16_f32 v57, v58, v59
    v_exp_f32 v62, v62
    v_add_u32 v2, 4096, v2
    v_exp_f32 v63, v63
    v_cvt_pk_bf16_f32 v58, v60, v61
    v_cvt_pk_bf16_f32 v59, v62, v63
    v_exp_f32 v32, v32
    v_exp_f32 v33, v33
    v_exp_f32 v34, v34
    v_mfma_f32_32x32x16_bf16 v[64:79], v[88:91], v[56:59], v[64:79]
    ds_read_b128 v[88:91], v3 offset:512
    v_cvt_pk_bf16_f32 v32, v32, v33
    v_exp_f32 v35, v35
    v_exp_f32 v36, v36
    v_exp_f32 v37, v37
    v_cvt_pk_bf16_f32 v33, v34, v35
    v_exp_f32 v38, v38
    v_exp_f32 v39, v39
    v_mfma_f32_32x32x16_bf16 v[48:63], v[80:83], v[4:7], v[16:31]
    ds_read_b128 v[80:83], v2 offset:2048
    s_waitcnt lgkmcnt(2)
    v_cvt_pk_bf16_f32 v34, v36, v37
    v_exp_f32 v40, v40
    v_exp_f32 v41, v41
    v_cvt_pk_bf16_f32 v35, v38, v39
    v_exp_f32 v42, v42
    v_exp_f32 v43, v43
    v_cvt_pk_bf16_f32 v40, v40, v41
    v_exp_f32 v44, v44
    v_mfma_f32_32x32x16_bf16 v[64:79], v[84:87], v[32:35], v[64:79]
    ds_read_b128 v[84:87], v3 offset:1024
    s_waitcnt lgkmcnt(1)
    v_exp_f32 v45, v45
    v_cvt_pk_bf16_f32 v41, v42, v43
    v_exp_f32 v46, v46
    v_exp_f32 v47, v47
    v_cvt_pk_bf16_f32 v42, v44, v45
    v_cvt_pk_bf16_f32 v43, v46, v47
    v_exp_f32 v48, v48
    v_exp_f32 v49, v49
    v_exp_f32 v50, v50
    v_mfma_f32_32x32x16_bf16 v[64:79], v[88:91], v[40:43], v[64:79]
    ds_read_b128 v[88:91], v3 offset:1536
    v_cvt_pk_bf16_f32 v48, v48, v49
    v_exp_f32 v51, v51
    v_exp_f32 v52, v52
    v_exp_f32 v53, v53
    v_cvt_pk_bf16_f32 v49, v50, v51
    v_exp_f32 v54, v54
    v_exp_f32 v55, v55
    v_mfma_f32_32x32x16_bf16 v[32:47], v[80:83], v[4:7], v[16:31]
    ds_read_b128 v[80:83], v2 offset:3072
    s_waitcnt lgkmcnt(2)
    v_cvt_pk_bf16_f32 v50, v52, v53
    v_exp_f32 v56, v56
    v_exp_f32 v57, v57
    v_cvt_pk_bf16_f32 v51, v54, v55
    v_exp_f32 v58, v58
    v_exp_f32 v59, v59
    v_cvt_pk_bf16_f32 v56, v56, v57
    v_exp_f32 v60, v60
    v_mfma_f32_32x32x16_bf16 v[64:79], v[84:87], v[48:51], v[64:79]
    ds_read_b128 v[84:87], v3 offset:2048
    s_waitcnt lgkmcnt(1)
    v_exp_f32 v61, v61
    v_cvt_pk_bf16_f32 v57, v58, v59
    v_exp_f32 v62, v62
    v_exp_f32 v63, v63
    v_cvt_pk_bf16_f32 v58, v60, v61
    v_cvt_pk_bf16_f32 v59, v62, v63
    s_setprio 0
    v_exp_f32 v32, v32
    v_exp_f32 v33, v33
    v_exp_f32 v34, v34
    v_mfma_f32_32x32x16_bf16 v[64:79], v[88:91], v[56:59], v[64:79]
    ds_read_b128 v[88:91], v3 offset:2560
    v_cvt_pk_bf16_f32 v32, v32, v33
    v_exp_f32 v35, v35
    v_exp_f32 v36, v36
    v_exp_f32 v37, v37
    v_cvt_pk_bf16_f32 v33, v34, v35
    v_exp_f32 v38, v38
    v_exp_f32 v39, v39
    v_mfma_f32_32x32x16_bf16 v[48:63], v[80:83], v[4:7], v[16:31]
    s_waitcnt lgkmcnt(1)
    v_cvt_pk_bf16_f32 v34, v36, v37
    v_exp_f32 v40, v40
    v_exp_f32 v41, v41
    v_cvt_pk_bf16_f32 v35, v38, v39
    v_exp_f32 v42, v42
    v_exp_f32 v43, v43
    v_cvt_pk_bf16_f32 v40, v40, v41
    v_exp_f32 v44, v44
    v_mfma_f32_32x32x16_bf16 v[64:79], v[84:87], v[32:35], v[64:79]
    ds_read_b128 v[84:87], v3 offset:3072
    s_waitcnt lgkmcnt(1)
    v_exp_f32 v45, v45
    v_cvt_pk_bf16_f32 v41, v42, v43
    v_exp_f32 v46, v46
    v_exp_f32 v47, v47
    v_cvt_pk_bf16_f32 v42, v44, v45
    v_cvt_pk_bf16_f32 v43, v46, v47
    v_exp_f32 v48, v48
    v_exp_f32 v49, v49
    v_exp_f32 v50, v50
    v_mfma_f32_32x32x16_bf16 v[64:79], v[88:91], v[40:43], v[64:79]
    ds_read_b128 v[88:91], v3 offset:3584
    v_cvt_pk_bf16_f32 v48, v48, v49
    v_exp_f32 v51, v51
    v_exp_f32 v52, v52
    v_exp_f32 v53, v53
    v_cvt_pk_bf16_f32 v49, v50, v51
    v_exp_f32 v54, v54
    v_exp_f32 v55, v55
    s_waitcnt lgkmcnt(1)
    v_cvt_pk_bf16_f32 v50, v52, v53
    v_exp_f32 v56, v56
    v_exp_f32 v57, v57
    v_cvt_pk_bf16_f32 v51, v54, v55
    v_exp_f32 v58, v58
    v_exp_f32 v59, v59
    v_cvt_pk_bf16_f32 v56, v56, v57
    v_add_u32 v3, v3, v12
    v_exp_f32 v60, v60
    v_mfma_f32_32x32x16_bf16 v[64:79], v[84:87], v[48:51], v[64:79]
    s_waitcnt lgkmcnt(0)
    v_exp_f32 v61, v61
    v_cvt_pk_bf16_f32 v57, v58, v59
    v_exp_f32 v62, v62
    v_add_u32 v2, 4096, v2
    v_exp_f32 v63, v63
    v_cvt_pk_bf16_f32 v58, v60, v61
    v_cvt_pk_bf16_f32 v59, v62, v63
    s_nop 1
    v_mfma_f32_32x32x16_bf16 v[64:79], v[88:91], v[56:59], v[64:79]
    v_mov_b32 v11, 0x71800000
    s_nop 10
    v_max3_f32 v14, |v64|, |v65|, |v66|
    v_max3_f32 v14, |v67|, |v68|, v14
    v_max3_f32 v14, |v69|, |v70|, v14
    v_max3_f32 v14, |v71|, |v72|, v14
    v_pk_add_f32 v[44:45], v[64:65], v[66:67]
    v_pk_add_f32 v[46:47], v[68:69], v[70:71]
    v_pk_add_f32 v[44:45], v[44:45], v[46:47]
    v_add_f32 v15, v44, v45
    v_add_f32 v15, v15, v72
    v_cmp_nlt_f32 vcc, v14, v11
    v_cmp_u_f32 s[22:23], v15, v15
    s_nop 0
    s_or_b64 vcc, vcc, s[22:23]
    s_cbranch_vccnz ATT_fb
ATT_ok:
    v_rcp_f32 v14, v72
    v_rcp_f32 v15, v72
    s_add_u32 s21, s61, s35
    s_add_u32 s20, s55, s35
    s_lshr_b32 s14, s3, 2
    s_and_b32 s15, s3, 3
    v_pk_mul_f32 v[64:65], v[64:65], v[14:15]
    v_pk_mul_f32 v[66:67], v[66:67], v[14:15]
    v_pk_mul_f32 v[68:69], v[68:69], v[14:15]
    v_pk_mul_f32 v[70:71], v[70:71], v[14:15]
    v_cvt_pk_bf16_f32 v80, v64, v65
    v_cvt_pk_bf16_f32 v81, v66, v67
    v_cvt_pk_bf16_f32 v82, v68, v69
    v_cvt_pk_bf16_f32 v83, v70, v71
    s_cmp_eq_u32 s29, 0
    s_cbranch_scc1 ST_slow_9
    buffer_store_dwordx4 v[80:83], v1, s[8:11], s21 offen
ST_done_10:
    s_add_u32 s32, s32, 1
    s_waitcnt vmcnt(0)
    s_barrier
    s_cmp_lg_u32 s3, 0
    s_cbranch_scc1 SIG_11
    v_mov_b32 v2, s32
    v_mov_b32 v3, 0
    s_mov_b64 exec, 1
    s_cmp_eq_u32 s29, 0
    s_cbranch_scc1 ST_slow_12
    buffer_store_dword v2, v3, s[8:11], s30 offen
ST_done_13:
    s_mov_b64 exec, -1
SIG_11:
    v_lshlrev_b32 v8, 16, v252
    v_and_b32 v9, 0xffff0000, v252
    v_lshlrev_b32 v10, 16, v253
    v_and_b32 v11, 0xffff0000, v253
    v_lshlrev_b32 v12, 16, v254
    v_and_b32 v13, 0xffff0000, v254
    v_lshlrev_b32 v14, 16, v255
    v_and_b32 v15, 0xffff0000, v255
    s_cmp_lg_u32 s3, 7
    s_cbranch_scc1 WAIT_14
    s_and_b32 s18, s30, 0xffffffe0
    v_and_b32 v2, 7, v0
    v_lshlrev_b32 v2, 2, v2
    s_mov_b32 s19, 0
POLL_15:
    buffer_load_dword v3, v2, s[8:11], s18 offen sc1
    s_add_u32 s19, s19, 1
    s_waitcnt vmcnt(0)
    v_cmp_gt_u32 vcc, s32, v3
    s_cmp_gt_u32 s19, 200000
    s_cbranch_scc1 POLLE_16
    s_cbranch_vccnz POLL_15
POLLE_16:
WAIT_14:
    s_barrier
    buffer_load_dwordx4 v[16:19], v1, s[8:11], s20 offen offset:0 sc1
    buffer_load_dwordx4 v[20:23], v1, s[8:11], s20 offen offset:1024 sc1
    buffer_load_dwordx4 v[24:27], v1, s[8:11], s20 offen offset:2048 sc1
    buffer_load_dwordx4 v[28:31], v1, s[8:11], s20 offen offset:3072 sc1
    s_add_u32 s19, s20, 4096
    buffer_load_dwordx4 v[32:35], v1, s[8:11], s19 offen offset:0 sc1
    buffer_load_dwordx4 v[36:39], v1, s[8:11], s19 offen offset:1024 sc1
    buffer_load_dwordx4 v[40:43], v1, s[8:11], s19 offen offset:2048 sc1
    buffer_load_dwordx4 v[44:47], v1, s[8:11], s19 offen offset:3072 sc1
    s_waitcnt vmcnt(7)
    v_mfma_f32_32x32x16_bf16 v[48:63], v[92:95], v[16:19], 0
    v_mfma_f32_32x32x16_bf16 v[64:79], v[124:127], v[16:19], 0
    s_waitcnt vmcnt(6)
    v_mfma_f32_32x32x16_bf16 v[48:63], v[96:99], v[20:23], v[48:63]
    v_mfma_f32_32x32x16_bf16 v[64:79], v[128:131], v[20:23], v[64:79]
    s_waitcnt vmcnt(5)
    v_mfma_f32_32x32x16_bf16 v[48:63], v[100:103], v[24:27], v[48:63]
    v_mfma_f32_32x32x16_bf16 v[64:79], v[132:135], v[24:27], v[64:79]
    s_waitcnt vmcnt(4)
    v_mfma_f32_32x32x16_bf16 v[48:63], v[104:107], v[28:31], v[48:63]
    v_mfma_f32_32x32x16_bf16 v[64:79], v[136:139], v[28:31], v[64:79]
    s_waitcnt vmcnt(3)
    v_mfma_f32_32x32x16_bf16 v[48:63], v[108:111], v[32:35], v[48:63]
    v_mfma_f32_32x32x16_bf16 v[64:79], v[140:143], v[32:35], v[64:79]
    s_waitcnt vmcnt(2)
    v_mfma_f32_32x32x16_bf16 v[48:63], v[112:115], v[36:39], v[48:63]
    v_mfma_f32_32x32x16_bf16 v[64:79], v[144:147], v[36:39], v[64:79]
    s_waitcnt vmcnt(1)
    v_mfma_f32_32x32x16_bf16 v[48:63], v[116:119], v[40:43], v[48:63]
    v_mfma_f32_32x32x16_bf16 v[64:79], v[148:151], v[40:43], v[64:79]
    s_waitcnt vmcnt(0)
    v_mfma_f32_32x32x16_bf16 v[48:63], v[120:123], v[44:47], v[48:63]
    v_mfma_f32_32x32x16_bf16 v[64:79], v[152:155], v[44:47], v[64:79]
    s_lshl_b32 s17, s14, 16
    s_lshl_b32 s18, s15, 11
    s_add_u32 s17, s17, s18
    s_add_u32 s17, s17, 8192
    s_lshl_b32 s18, s14, 14
    s_add_u32 s16, s18, s17
    v_add_u32 v2, s16, v1
    s_xor_b32 s18, s18, 0x4000
    s_add_u32 s16, s18, s17
    v_add_u32 v3, s16, v1
    s_nop 0
    ds_write_b128 v2, v[48:51] offset:0
    ds_write_b128 v2, v[52:55] offset:1024
    ds_write_b128 v2, v[56:59] offset:8192
    ds_write_b128 v2, v[60:63] offset:9216
    ds_write_b128 v3, v[64:67] offset:0
    ds_write_b128 v3, v[68:71] offset:1024
    ds_write_b128 v3, v[72:75] offset:8192
    ds_write_b128 v3, v[76:79] offset:9216
    s_add_u32 s19, s36, 24576
    buffer_load_dwordx4 v[124:127], v1, s[8:11], s19 offen offset:0
    buffer_load_dwordx4 v[128:131], v1, s[8:11], s19 offen offset:1024
    buffer_load_dwordx4 v[132:135], v1, s[8:11], s19 offen offset:2048
    buffer_load_dwordx4 v[136:139], v1, s[8:11], s19 offen offset:3072
    s_add_u32 s19, s36, 28672
    buffer_load_dwordx4 v[140:143], v1, s[8:11], s19 offen offset:0
    buffer_load_dwordx4 v[144:147], v1, s[8:11], s19 offen offset:1024
    buffer_load_dwordx4 v[148:151], v1, s[8:11], s19 offen offset:2048
    buffer_load_dwordx4 v[152:155], v1, s[8:11], s19 offen offset:3072
    s_lshl_b32 s20, s14, 16
    s_lshl_b32 s17, s15, 13
    s_add_u32 s20, s20, s17
    s_add_u32 s20, s20, 8192
    v_add_u32 v3, s20, v1
    s_add_u32 s21, s21, 4194304
    s_lshr_b32 s22, s61, 2
    s_add_u32 s22, s22, s35
    s_add_u32 s22, s22, 6291456
    v_mov_b32 v4, 0
    v_mov_b32 v5, 0
    v_mov_b32 v6, 0x3f803f80
    v_lshrrev_b32 v7, 1, v1
    s_waitcnt lgkmcnt(0)
    s_barrier
    ds_read_b128 v[16:19], v3 offset:0
    ds_read_b128 v[20:23], v3 offset:1024
    ds_read_b128 v[24:27], v3 offset:2048
    ds_read_b128 v[28:31], v3 offset:3072
    ds_read_b128 v[32:35], v3 offset:4096
    ds_read_b128 v[36:39], v3 offset:5120
    ds_read_b128 v[40:43], v3 offset:6144
    ds_read_b128 v[44:47], v3 offset:7168
    s_waitcnt lgkmcnt(6)
    v_pk_add_f32 v[8:9], v[8:9], v[16:17]
    v_pk_add_f32 v[10:11], v[10:11], v[18:19]
    v_pk_add_f32 v[12:13], v[12:13], v[20:21]
    v_pk_add_f32 v[14:15], v[14:15], v[22:23]
    s_waitcnt lgkmcnt(4)
    v_pk_add_f32 v[8:9], v[8:9], v[24:25]
    v_pk_add_f32 v[10:11], v[10:11], v[26:27]
    v_pk_add_f32 v[12:13], v[12:13], v[28:29]
    v_pk_add_f32 v[14:15], v[14:15], v[30:31]
    s_waitcnt lgkmcnt(2)
    v_pk_add_f32 v[8:9], v[8:9], v[32:33]
    v_pk_add_f32 v[10:11], v[10:11], v[34:35]
    v_pk_add_f32 v[12:13], v[12:13], v[36:37]
    v_pk_add_f32 v[14:15], v[14:15], v[38:39]
    s_waitcnt lgkmcnt(0)
    v_pk_add_f32 v[8:9], v[8:9], v[40:41]
    v_pk_add_f32 v[10:11], v[10:11], v[42:43]
    v_pk_add_f32 v[12:13], v[12:13], v[44:45]
    v_pk_add_f32 v[14:15], v[14:15], v[46:47]
    v_cvt_pk_bf16_f32 v252, v8, v9
    v_cvt_pk_bf16_f32 v253, v10, v11
    v_cvt_pk_bf16_f32 v254, v12, v13
    v_cvt_pk_bf16_f32 v255, v14, v15
    s_cmp_eq_u32 s29, 0
    s_cbranch_scc1 ST_slow_18
    buffer_store_dwordx4 v[252:255], v1, s[8:11], s21 offen
ST_done_19:
    v_dot2c_f32_bf16 v4, v252, v6
    v_dot2c_f32_bf16 v5, v252, v252
    v_dot2c_f32_bf16 v4, v253, v6
    v_dot2c_f32_bf16 v5, v253, v253
    v_dot2c_f32_bf16 v4, v254, v6
    v_dot2c_f32_bf16 v5, v254, v254
    v_dot2c_f32_bf16 v4, v255, v6
    v_dot2c_f32_bf16 v5, v255, v255
    s_nop 1
    v_mov_b32 v16, v4
    v_mov_b32 v17, v5
    s_nop 0
    v_permlane32_swap_b32 v4, v16
    v_permlane32_swap_b32 v5, v17
    v_pk_add_f32 v[4:5], v[4:5], v[16:17]
    s_mov_b32 exec_hi, 0
    s_cmp_eq_u32 s29, 0
    s_cbranch_scc1 ST_slow_20
    buffer_store_dwordx2 v[4:5], v7, s[8:11], s22 offen
ST_done_21:
    s_mov_b32 exec_hi, -1
    s_add_u32 s32, s32, 1
    s_waitcnt vmcnt(0)
    s_barrier
    s_cmp_lg_u32 s3, 0
    s_cbranch_scc1 SIG_22
    v_mov_b32 v2, s32
    v_mov_b32 v3, 0
    s_mov_b64 exec, 1
    s_cmp_eq_u32 s29, 0
    s_cbranch_scc1 ST_slow_23
    buffer_store_dword v2, v3, s[8:11], s30 offen
ST_done_24:
    s_mov_b64 exec, -1
SIG_22:
    s_cmp_eq_u32 s3, 7
    s_cbranch_scc1 GU_loader
    s_add_u32 s14, s58, 229376
    v_and_b32 v10, 15, v0
    v_lshlrev_b32 v11, 4, v10
    v_bfe_u32 v12, v0, 4, 2
    v_lshl_add_u32 v2, v12, 9, v11
    v_add_u32 v3, 65536, v2
    v_bfe_u32 v14, v0, 4, 1
    v_lshl_add_u32 v14, v14, 9, v11
    v_bfe_u32 v15, v0, 5, 1
    v_lshl_add_u32 v14, v15, 8, v14
    v_add_u32 v11, 135168, v11
    s_lshl_b32 s17, s3, 7
    s_add_u32 s17, s17, 137216
    v_lshl_add_u32 v12, v12, 4, s17
    s_cmp_lg_u32 s33, 0
    s_cbranch_scc1 GU_nocs
    v_lshl_add_u32 v10, v10, 2, s17
    v_mov_b32 v8, 0x3f803f80
    v_mov_b32 v4, 0
    v_mov_b32 v5, 0
    v_dot2c_f32_bf16 v4, v156, v8
    v_dot2c_f32_bf16 v5, v160, v8
    v_dot2c_f32_bf16 v4, v157, v8
    v_dot2c_f32_bf16 v5, v161, v8
    v_dot2c_f32_bf16 v4, v158, v8
    v_dot2c_f32_bf16 v5, v162, v8
    v_dot2c_f32_bf16 v4, v159, v8
    v_dot2c_f32_bf16 v5, v163, v8
    v_dot2c_f32_bf16 v4, v164, v8
    v_dot2c_f32_bf16 v5, v168, v8
    v_dot2c_f32_bf16 v4, v165, v8
    v_dot2c_f32_bf16 v5, v169, v8
    v_dot2c_f32_bf16 v4, v166, v8
    v_dot2c_f32_bf16 v5, v170, v8
    v_dot2c_f32_bf16 v4, v167, v8
    v_dot2c_f32_bf16 v5, v171, v8
    v_dot2c_f32_bf16 v4, v172, v8
    v_dot2c_f32_bf16 v5, v176, v8
    v_dot2c_f32_bf16 v4, v173, v8
    v_dot2c_f32_bf16 v5, v177, v8
    v_dot2c_f32_bf16 v4, v174, v8
    v_dot2c_f32_bf16 v5, v178, v8
    v_dot2c_f32_bf16 v4, v175, v8
    v_dot2c_f32_bf16 v5, v179, v8
    v_dot2c_f32_bf16 v4, v180, v8
    v_dot2c_f32_bf16 v5, v184, v8
    v_dot2c_f32_bf16 v4, v181, v8
    v_dot2c_f32_bf16 v5, v185, v8
    v_dot2c_f32_bf16 v4, v182, v8
    v_dot2c_f32_bf16 v5, v186, v8
    v_dot2c_f32_bf16 v4, v183, v8
    v_dot2c_f32_bf16 v5, v187, v8
    v_dot2c_f32_bf16 v4, v188, v8
    v_dot2c_f32_bf16 v5, v192, v8
    v_dot2c_f32_bf16 v4, v189, v8
    v_dot2c_f32_bf16 v5, v193, v8
    v_dot2c_f32_bf16 v4, v190, v8
    v_dot2c_f32_bf16 v5, v194, v8
    v_dot2c_f32_bf16 v4, v191, v8
    v_dot2c_f32_bf16 v5, v195, v8
    v_dot2c_f32_bf16 v4, v196, v8
    v_dot2c_f32_bf16 v5, v200, v8
    v_dot2c_f32_bf16 v4, v197, v8
    v_dot2c_f32_bf16 v5, v201, v8
    v_dot2c_f32_bf16 v4, v198, v8
    v_dot2c_f32_bf16 v5, v202, v8
    v_dot2c_f32_bf16 v4, v199, v8
    v_dot2c_f32_bf16 v5, v203, v8
    v_dot2c_f32_bf16 v4, v204, v8
    v_dot2c_f32_bf16 v5, v208, v8
    v_dot2c_f32_bf16 v4, v205, v8
    v_dot2c_f32_bf16 v5, v209, v8
    v_dot2c_f32_bf16 v4, v206, v8
    v_dot2c_f32_bf16 v5, v210, v8
    v_dot2c_f32_bf16 v4, v207, v8
    v_dot2c_f32_bf16 v5, v211, v8
    v_dot2c_f32_bf16 v4, v212, v8
    v_dot2c_f32_bf16 v5, v216, v8
    v_dot2c_f32_bf16 v4, v213, v8
    v_dot2c_f32_bf16 v5, v217, v8
    v_dot2c_f32_bf16 v4, v214, v8
    v_dot2c_f32_bf16 v5, v218, v8
    v_dot2c_f32_bf16 v4, v215, v8
    v_dot2c_f32_bf16 v5, v219, v8
    v_dot2c_f32_bf16 v4, v220, v8
    v_dot2c_f32_bf16 v5, v224, v8
    v_dot2c_f32_bf16 v4, v221, v8
    v_dot2c_f32_bf16 v5, v225, v8
    v_dot2c_f32_bf16 v4, v222, v8
    v_dot2c_f32_bf16 v5, v226, v8
    v_dot2c_f32_bf16 v4, v223, v8
    v_dot2c_f32_bf16 v5, v227, v8
    v_dot2c_f32_bf16 v4, v228, v8
    v_dot2c_f32_bf16 v5, v232, v8
    v_dot2c_f32_bf16 v4, v229, v8
    v_dot2c_f32_bf16 v5, v233, v8
    v_dot2c_f32_bf16 v4, v230, v8
    v_dot2c_f32_bf16 v5, v234, v8
    v_dot2c_f32_bf16 v4, v231, v8
    v_dot2c_f32_bf16 v5, v235, v8
    v_dot2c_f32_bf16 v4, v236, v8
    v_dot2c_f32_bf16 v5, v240, v8
    v_dot2c_f32_bf16 v4, v237, v8
    v_dot2c_f32_bf16 v5, v241, v8
    v_dot2c_f32_bf16 v4, v238, v8
    v_dot2c_f32_bf16 v5, v242, v8
    v_dot2c_f32_bf16 v4, v239, v8
    v_dot2c_f32_bf16 v5, v243, v8
    v_dot2c_f32_bf16 v4, v244, v8
    v_dot2c_f32_bf16 v5, v248, v8
    v_dot2c_f32_bf16 v4, v245, v8
    v_dot2c_f32_bf16 v5, v249, v8
    v_dot2c_f32_bf16 v4, v246, v8
    v_dot2c_f32_bf16 v5, v250, v8
    v_dot2c_f32_bf16 v4, v247, v8
    v_dot2c_f32_bf16 v5, v251, v8
    v_dot2c_f32_bf16 v4, v124, v8
    v_dot2c_f32_bf16 v5, v128, v8
    v_dot2c_f32_bf16 v4, v125, v8
    v_dot2c_f32_bf16 v5, v129, v8
    v_dot2c_f32_bf16 v4, v126, v8
    v_dot2c_f32_bf16 v5, v130, v8
    v_dot2c_f32_bf16 v4, v127, v8
    v_dot2c_f32_bf16 v5, v131, v8
    v_dot2c_f32_bf16 v4, v132, v8
    v_dot2c_f32_bf16 v5, v136, v8
    v_dot2c_f32_bf16 v4, v133, v8
    v_dot2c_f32_bf16 v5, v137, v8
    v_dot2c_f32_bf16 v4, v134, v8
    v_dot2c_f32_bf16 v5, v138, v8
    v_dot2c_f32_bf16 v4, v135, v8
    v_dot2c_f32_bf16 v5, v139, v8
    v_dot2c_f32_bf16 v4, v140, v8
    v_dot2c_f32_bf16 v5, v144, v8
    v_dot2c_f32_bf16 v4, v141, v8
    v_dot2c_f32_bf16 v5, v145, v8
    v_dot2c_f32_bf16 v4, v142, v8
    v_dot2c_f32_bf16 v5, v146, v8
    v_dot2c_f32_bf16 v4, v143, v8
    v_dot2c_f32_bf16 v5, v147, v8
    v_dot2c_f32_bf16 v4, v148, v8
    v_dot2c_f32_bf16 v5, v152, v8
    v_dot2c_f32_bf16 v4, v149, v8
    v_dot2c_f32_bf16 v5, v153, v8
    v_dot2c_f32_bf16 v4, v150, v8
    v_dot2c_f32_bf16 v5, v154, v8
    v_dot2c_f32_bf16 v4, v151, v8
    v_dot2c_f32_bf16 v5, v155, v8
    s_nop 1
    v_mov_b32 v6, v4
    v_mov_b32 v7, v5
    s_nop 0
    v_permlane32_swap_b32 v4, v6
    v_permlane32_swap_b32 v5, v7
    v_add_f32 v4, v4, v6
    v_add_f32 v5, v5, v7
    v_mov_b32 v6, v4
    v_mov_b32 v7, v5
    s_nop 0
    v_permlane16_swap_b32 v4, v6
    v_permlane16_swap_b32 v5, v7
    v_add_f32 v4, v4, v6
    v_add_f32 v5, v5, v7
    ds_write_b32 v10, v4
    ds_write_b32 v10, v5 offset:64
GU_nocs:
    s_barrier
    ds_read_b128 v[80:83], v2 offset:0
    ds_read_b128 v[84:87], v2 offset:256
    ds_read_b128 v[88:91], v2 offset:32768
    ds_read_b128 v[92:95], v2 offset:33024
    ds_read_b128 v[96:99], v3 offset:0
    ds_read_b128 v[100:103], v3 offset:256
    ds_read_b128 v[104:107], v3 offset:32768
    ds_read_b128 v[108:111], v3 offset:33024
    s_waitcnt lgkmcnt(6)
    v_mfma_f32_16x16x32_bf16 v[16:19], v[156:159], v[80:83], 0
    ds_read_b128 v[112:115], v2 offset:2048
    v_mfma_f32_16x16x32_bf16 v[20:23], v[160:163], v[80:83], 0
    v_mfma_f32_16x16x32_bf16 v[24:27], v[156:159], v[84:87], 0
    ds_read_b128 v[116:119], v2 offset:2304
    v_mfma_f32_16x16x32_bf16 v[28:31], v[160:163], v[84:87], 0
    s_waitcnt lgkmcnt(6)
    v_mfma_f32_16x16x32_bf16 v[32:35], v[156:159], v[88:91], 0
    ds_read_b128 v[120:123], v2 offset:34816
    v_mfma_f32_16x16x32_bf16 v[36:39], v[160:163], v[88:91], 0
    v_mfma_f32_16x16x32_bf16 v[40:43], v[156:159], v[92:95], 0
    ds_read_b128 v[4:7], v2 offset:35072
    v_mfma_f32_16x16x32_bf16 v[44:47], v[160:163], v[92:95], 0
    s_waitcnt lgkmcnt(6)
    v_mfma_f32_16x16x32_bf16 v[48:51], v[156:159], v[96:99], 0
    ds_read_b128 v[80:83], v3 offset:2048
    v_mfma_f32_16x16x32_bf16 v[52:55], v[160:163], v[96:99], 0
    v_mfma_f32_16x16x32_bf16 v[56:59], v[156:159], v[100:103], 0
    ds_read_b128 v[84:87], v3 offset:2304
    v_mfma_f32_16x16x32_bf16 v[60:63], v[160:163], v[100:103], 0
    s_waitcnt lgkmcnt(6)
    v_mfma_f32_16x16x32_bf16 v[64:67], v[156:159], v[104:107], 0
    ds_read_b128 v[88:91], v3 offset:34816
    v_mfma_f32_16x16x32_bf16 v[68:71], v[160:163], v[104:107], 0
    v_mfma_f32_16x16x32_bf16 v[72:75], v[156:159], v[108:111], 0
    ds_read_b128 v[92:95], v3 offset:35072
    v_mfma_f32_16x16x32_bf16 v[76:79], v[160:163], v[108:111], 0
    s_barrier
    s_waitcnt lgkmcnt(6)
    v_mfma_f32_16x16x32_bf16 v[16:19], v[164:167], v[112:115], v[16:19]
    ds_read_b128 v[96:99], v2 offset:4096
    v_mfma_f32_16x16x32_bf16 v[20:23], v[168:171], v[112:115], v[20:23]
    v_mfma_f32_16x16x32_bf16 v[24:27], v[164:167], v[116:119], v[24:27]
    ds_read_b128 v[100:103], v2 offset:4352
    v_mfma_f32_16x16x32_bf16 v[28:31], v[168:171], v[116:119], v[28:31]
    s_waitcnt lgkmcnt(6)
    v_mfma_f32_16x16x32_bf16 v[32:35], v[164:167], v[120:123], v[32:35]
    ds_read_b128 v[104:107], v2 offset:36864
    v_mfma_f32_16x16x32_bf16 v[36:39], v[168:171], v[120:123], v[36:39]
    v_mfma_f32_16x16x32_bf16 v[40:43], v[164:167], v[4:7], v[40:43]
    ds_read_b128 v[108:111], v2 offset:37120
    v_mfma_f32_16x16x32_bf16 v[44:47], v[168:171], v[4:7], v[44:47]
    s_waitcnt lgkmcnt(6)
    v_mfma_f32_16x16x32_bf16 v[48:51], v[164:167], v[80:83], v[48:51]
    ds_read_b128 v[112:115], v3 offset:4096
    v_mfma_f32_16x16x32_bf16 v[52:55], v[168:171], v[80:83], v[52:55]
    v_mfma_f32_16x16x32_bf16 v[56:59], v[164:167], v[84:87], v[56:59]
    ds_read_b128 v[116:119], v3 offset:4352
    v_mfma_f32_16x16x32_bf16 v[60:63], v[168:171], v[84:87], v[60:63]
    s_waitcnt lgkmcnt(6)
    v_mfma_f32_16x16x32_bf16 v[64:67], v[164:167], v[88:91], v[64:67]
    ds_read_b128 v[120:123], v3 offset:36864
    v_mfma_f32_16x16x32_bf16 v[68:71], v[168:171], v[88:91], v[68:71]
    v_mfma_f32_16x16x32_bf16 v[72:75], v[164:167], v[92:95], v[72:75]
    ds_read_b128 v[4:7], v3 offset:37120
    v_mfma_f32_16x16x32_bf16 v[76:79], v[168:171], v[92:95], v[76:79]
    s_waitcnt lgkmcnt(6)
    v_mfma_f32_16x16x32_bf16 v[16:19], v[172:175], v[96:99], v[16:19]
    ds_read_b128 v[80:83], v2 offset:6144
    v_mfma_f32_16x16x32_bf16 v[20:23], v[176:179], v[96:99], v[20:23]
    v_mfma_f32_16x16x32_bf16 v[24:27], v[172:175], v[100:103], v[24:27]
    ds_read_b128 v[84:87], v2 offset:6400
    v_mfma_f32_16x16x32_bf16 v[28:31], v[176:179], v[100:103], v[28:31]
    s_waitcnt lgkmcnt(6)
    v_mfma_f32_16x16x32_bf16 v[32:35], v[172:175], v[104:107], v[32:35]
    ds_read_b128 v[88:91], v2 offset:38912
    v_mfma_f32_16x16x32_bf16 v[36:39], v[176:179], v[104:107], v[36:39]
    buffer_load_dwordx4 v[156:159], v1, s[8:11], s37 offen offset:0
    v_mfma_f32_16x16x32_bf16 v[40:43], v[172:175], v[108:111], v[40:43]
    ds_read_b128 v[92:95], v2 offset:39168
    v_mfma_f32_16x16x32_bf16 v[44:47], v[176:179], v[108:111], v[44:47]
    s_waitcnt lgkmcnt(6)
    v_mfma_f32_16x16x32_bf16 v[48:51], v[172:175], v[112:115], v[48:51]
    ds_read_b128 v[96:99], v3 offset:6144
    v_mfma_f32_16x16x32_bf16 v[52:55], v[176:179], v[112:115], v[52:55]
    v_mfma_f32_16x16x32_bf16 v[56:59], v[172:175], v[116:119], v[56:59]
    ds_read_b128 v[100:103], v3 offset:6400
    v_mfma_f32_16x16x32_bf16 v[60:63], v[176:179], v[116:119], v[60:63]
    s_waitcnt lgkmcnt(6)
    v_mfma_f32_16x16x32_bf16 v[64:67], v[172:175], v[120:123], v[64:67]
    ds_read_b128 v[104:107], v3 offset:38912
    v_mfma_f32_16x16x32_bf16 v[68:71], v[176:179], v[120:123], v[68:71]
    buffer_load_dwordx4 v[160:163], v1, s[8:11], s37 offen offset:1024
    v_mfma_f32_16x16x32_bf16 v[72:75], v[172:175], v[4:7], v[72:75]
    ds_read_b128 v[108:111], v3 offset:39168
    v_mfma_f32_16x16x32_bf16 v[76:79], v[176:179], v[4:7], v[76:79]
    s_barrier
    s_waitcnt lgkmcnt(6)
    v_mfma_f32_16x16x32_bf16 v[16:19], v[180:183], v[80:83], v[16:19]
    ds_read_b128 v[112:115], v2 offset:8192
    v_mfma_f32_16x16x32_bf16 v[20:23], v[184:187], v[80:83], v[20:23]
    v_mfma_f32_16x16x32_bf16 v[24:27], v[180:183], v[84:87], v[24:27]
    ds_read_b128 v[116:119], v2 offset:8448
    v_mfma_f32_16x16x32_bf16 v[28:31], v[184:187], v[84:87], v[28:31]
    s_waitcnt lgkmcnt(6)
    v_mfma_f32_16x16x32_bf16 v[32:35], v[180:183], v[88:91], v[32:35]
    ds_read_b128 v[120:123], v2 offset:40960
    v_mfma_f32_16x16x32_bf16 v[36:39], v[184:187], v[88:91], v[36:39]
    buffer_load_dwordx4 v[164:167], v1, s[8:11], s37 offen offset:2048
    v_mfma_f32_16x16x32_bf16 v[40:43], v[180:183], v[92:95], v[40:43]
    ds_read_b128 v[4:7], v2 offset:41216
    v_mfma_f32_16x16x32_bf16 v[44:47], v[184:187], v[92:95], v[44:47]
    s_waitcnt lgkmcnt(6)
    v_mfma_f32_16x16x32_bf16 v[48:51], v[180:183], v[96:99], v[48:51]
    ds_read_b128 v[80:83], v3 offset:8192
    v_mfma_f32_16x16x32_bf16 v[52:55], v[184:187], v[96:99], v[52:55]
    v_mfma_f32_16x16x32_bf16 v[56:59], v[180:183], v[100:103], v[56:59]
    ds_read_b128 v[84:87], v3 offset:8448
    v_mfma_f32_16x16x32_bf16 v[60:63], v[184:187], v[100:103], v[60:63]
    s_waitcnt lgkmcnt(6)
    v_mfma_f32_16x16x32_bf16 v[64:67], v[180:183], v[104:107], v[64:67]
    ds_read_b128 v[88:91], v3 offset:40960
    v_mfma_f32_16x16x32_bf16 v[68:71], v[184:187], v[104:107], v[68:71]
    buffer_load_dwordx4 v[168:171], v1, s[8:11], s37 offen offset:3072
    v_mfma_f32_16x16x32_bf16 v[72:75], v[180:183], v[108:111], v[72:75]
    ds_read_b128 v[92:95], v3 offset:41216
    v_mfma_f32_16x16x32_bf16 v[76:79], v[184:187], v[108:111], v[76:79]
    s_waitcnt lgkmcnt(6)
    v_mfma_f32_16x16x32_bf16 v[16:19], v[188:191], v[112:115], v[16:19]
    ds_read_b128 v[96:99], v2 offset:10240
    v_mfma_f32_16x16x32_bf16 v[20:23], v[192:195], v[112:115], v[20:23]
    v_mfma_f32_16x16x32_bf16 v[24:27], v[188:191], v[116:119], v[24:27]
    ds_read_b128 v[100:103], v2 offset:10496
    v_mfma_f32_16x16x32_bf16 v[28:31], v[192:195], v[116:119], v[28:31]
    s_waitcnt lgkmcnt(6)
    v_mfma_f32_16x16x32_bf16 v[32:35], v[188:191], v[120:123], v[32:35]
    ds_read_b128 v[104:107], v2 offset:43008
    v_mfma_f32_16x16x32_bf16 v[36:39], v[192:195], v[120:123], v[36:39]
    s_add_u32 s19, s37, 4096
    buffer_load_dwordx4 v[172:175], v1, s[8:11], s19 offen offset:0
    v_mfma_f32_16x16x32_bf16 v[40:43], v[188:191], v[4:7], v[40:43]
    ds_read_b128 v[108:111], v2 offset:43264
    v_mfma_f32_16x16x32_bf16 v[44:47], v[192:195], v[4:7], v[44:47]
    s_waitcnt lgkmcnt(6)
    v_mfma_f32_16x16x32_bf16 v[48:51], v[188:191], v[80:83], v[48:51]
    ds_read_b128 v[112:115], v3 offset:10240
    v_mfma_f32_16x16x32_bf16 v[52:55], v[192:195], v[80:83], v[52:55]
    v_mfma_f32_16x16x32_bf16 v[56:59], v[188:191], v[84:87], v[56:59]
    ds_read_b128 v[116:119], v3 offset:10496
    v_mfma_f32_16x16x32_bf16 v[60:63], v[192:195], v[84:87], v[60:63]
    s_waitcnt lgkmcnt(6)
    v_mfma_f32_16x16x32_bf16 v[64:67], v[188:191], v[88:91], v[64:67]
    ds_read_b128 v[120:123], v3 offset:43008
    v_mfma_f32_16x16x32_bf16 v[68:71], v[192:195], v[88:91], v[68:71]
    s_add_u32 s19, s37, 4096
    buffer_load_dwordx4 v[176:179], v1, s[8:11], s19 offen offset:1024
    v_mfma_f32_16x16x32_bf16 v[72:75], v[188:191], v[92:95], v[72:75]
    ds_read_b128 v[4:7], v3 offset:43264
    v_mfma_f32_16x16x32_bf16 v[76:79], v[192:195], v[92:95], v[76:79]
    s_waitcnt lgkmcnt(6)
    v_mfma_f32_16x16x32_bf16 v[16:19], v[196:199], v[96:99], v[16:19]
    ds_read_b128 v[80:83], v2 offset:12288
    v_mfma_f32_16x16x32_bf16 v[20:23], v[200:203], v[96:99], v[20:23]
    v_mfma_f32_16x16x32_bf16 v[24:27], v[196:199], v[100:103], v[24:27]
    ds_read_b128 v[84:87], v2 offset:12544
    v_mfma_f32_16x16x32_bf16 v[28:31], v[200:203], v[100:103], v[28:31]
    s_waitcnt lgkmcnt(6)
    v_mfma_f32_16x16x32_bf16 v[32:35], v[196:199], v[104:107], v[32:35]
    ds_read_b128 v[88:91], v2 offset:45056
    v_mfma_f32_16x16x32_bf16 v[36:39], v[200:203], v[104:107], v[36:39]
    s_add_u32 s19, s37, 4096
    buffer_load_dwordx4 v[180:183], v1, s[8:11], s19 offen offset:2048
    v_mfma_f32_16x16x32_bf16 v[40:43], v[196:199], v[108:111], v[40:43]
    ds_read_b128 v[92:95], v2 offset:45312
    v_mfma_f32_16x16x32_bf16 v[44:47], v[200:203], v[108:111], v[44:47]
    s_waitcnt lgkmcnt(6)
    v_mfma_f32_16x16x32_bf16 v[48:51], v[196:199], v[112:115], v[48:51]
    ds_read_b128 v[96:99], v3 offset:12288
    v_mfma_f32_16x16x32_bf16 v[52:55], v[200:203], v[112:115], v[52:55]
    v_mfma_f32_16x16x32_bf16 v[56:59], v[196:199], v[116:119], v[56:59]
    ds_read_b128 v[100:103], v3 offset:12544
    v_mfma_f32_16x16x32_bf16 v[60:63], v[200:203], v[116:119], v[60:63]
    s_waitcnt lgkmcnt(6)
    v_mfma_f32_16x16x32_bf16 v[64:67], v[196:199], v[120:123], v[64:67]
    ds_read_b128 v[104:107], v3 offset:45056
    v_mfma_f32_16x16x32_bf16 v[68:71], v[200:203], v[120:123], v[68:71]
    s_add_u32 s19, s37, 4096
    buffer_load_dwordx4 v[184:187], v1, s[8:11], s19 offen offset:3072
    v_mfma_f32_16x16x32_bf16 v[72:75], v[196:199], v[4:7], v[72:75]
    ds_read_b128 v[108:111], v3 offset:45312
    v_mfma_f32_16x16x32_bf16 v[76:79], v[200:203], v[4:7], v[76:79]
    s_waitcnt lgkmcnt(6)
    v_mfma_f32_16x16x32_bf16 v[16:19], v[204:207], v[80:83], v[16:19]
    ds_read_b128 v[112:115], v2 offset:14336
    v_mfma_f32_16x16x32_bf16 v[20:23], v[208:211], v[80:83], v[20:23]
    v_mfma_f32_16x16x32_bf16 v[24:27], v[204:207], v[84:87], v[24:27]
    ds_read_b128 v[116:119], v2 offset:14592
    v_mfma_f32_16x16x32_bf16 v[28:31], v[208:211], v[84:87], v[28:31]
    s_waitcnt lgkmcnt(6)
    v_mfma_f32_16x16x32_bf16 v[32:35], v[204:207], v[88:91], v[32:35]
    ds_read_b128 v[120:123], v2 offset:47104
    v_mfma_f32_16x16x32_bf16 v[36:39], v[208:211], v[88:91], v[36:39]
    s_add_u32 s19, s37, 8192
    buffer_load_dwordx4 v[188:191], v1, s[8:11], s19 offen offset:0
    v_mfma_f32_16x16x32_bf16 v[40:43], v[204:207], v[92:95], v[40:43]
    ds_read_b128 v[4:7], v2 offset:47360
    v_mfma_f32_16x16x32_bf16 v[44:47], v[208:211], v[92:95], v[44:47]
    s_waitcnt lgkmcnt(6)
    v_mfma_f32_16x16x32_bf16 v[48:51], v[204:207], v[96:99], v[48:51]
    ds_read_b128 v[80:83], v3 offset:14336
    v_mfma_f32_16x16x32_bf16 v[52:55], v[208:211], v[96:99], v[52:55]
    v_mfma_f32_16x16x32_bf16 v[56:59], v[204:207], v[100:103], v[56:59]
    ds_read_b128 v[84:87], v3 offset:14592
    v_mfma_f32_16x16x32_bf16 v[60:63], v[208:211], v[100:103], v[60:63]
    s_waitcnt lgkmcnt(6)
    v_mfma_f32_16x16x32_bf16 v[64:67], v[204:207], v[104:107], v[64:67]
    ds_read_b128 v[88:91], v3 offset:47104
    v_mfma_f32_16x16x32_bf16 v[68:71], v[208:211], v[104:107], v[68:71]
    s_add_u32 s19, s37, 8192
    buffer_load_dwordx4 v[192:195], v1, s[8:11], s19 offen offset:1024
    v_mfma_f32_16x16x32_bf16 v[72:75], v[204:207], v[108:111], v[72:75]
    ds_read_b128 v[92:95], v3 offset:47360
    v_mfma_f32_16x16x32_bf16 v[76:79], v[208:211], v[108:111], v[76:79]
    s_barrier
    s_waitcnt lgkmcnt(6)
    v_mfma_f32_16x16x32_bf16 v[16:19], v[212:215], v[112:115], v[16:19]
    ds_read_b128 v[96:99], v2 offset:16384
    v_mfma_f32_16x16x32_bf16 v[20:23], v[216:219], v[112:115], v[20:23]
    v_mfma_f32_16x16x32_bf16 v[24:27], v[212:215], v[116:119], v[24:27]
    ds_read_b128 v[100:103], v2 offset:16640
    v_mfma_f32_16x16x32_bf16 v[28:31], v[216:219], v[116:119], v[28:31]
    s_waitcnt lgkmcnt(6)
    v_mfma_f32_16x16x32_bf16 v[32:35], v[212:215], v[120:123], v[32:35]
    ds_read_b128 v[104:107], v2 offset:49152
    v_mfma_f32_16x16x32_bf16 v[36:39], v[216:219], v[120:123], v[36:39]
    s_add_u32 s19, s37, 8192
    buffer_load_dwordx4 v[196:199], v1, s[8:11], s19 offen offset:2048
    v_mfma_f32_16x16x32_bf16 v[40:43], v[212:215], v[4:7], v[40:43]
    ds_read_b128 v[108:111], v2 offset:49408
    v_mfma_f32_16x16x32_bf16 v[44:47], v[216:219], v[4:7], v[44:47]
    s_waitcnt lgkmcnt(6)
    v_mfma_f32_16x16x32_bf16 v[48:51], v[212:215], v[80:83], v[48:51]
    ds_read_b128 v[112:115], v3 offset:16384
    v_mfma_f32_16x16x32_bf16 v[52:55], v[216:219], v[80:83], v[52:55]
    v_mfma_f32_16x16x32_bf16 v[56:59], v[212:215], v[84:87], v[56:59]
    ds_read_b128 v[116:119], v3 offset:16640
    v_mfma_f32_16x16x32_bf16 v[60:63], v[216:219], v[84:87], v[60:63]
    s_waitcnt lgkmcnt(6)
    v_mfma_f32_16x16x32_bf16 v[64:67], v[212:215], v[88:91], v[64:67]
    ds_read_b128 v[120:123], v3 offset:49152
    v_mfma_f32_16x16x32_bf16 v[68:71], v[216:219], v[88:91], v[68:71]
    s_add_u32 s19, s37, 8192
    buffer_load_dwordx4 v[200:203], v1, s[8:11], s19 offen offset:3072
    v_mfma_f32_16x16x32_bf16 v[72:75], v[212:215], v[92:95], v[72:75]
    ds_read_b128 v[4:7], v3 offset:49408
    v_mfma_f32_16x16x32_bf16 v[76:79], v[216:219], v[92:95], v[76:79]
    s_waitcnt lgkmcnt(6)
    v_mfma_f32_16x16x32_bf16 v[16:19], v[220:223], v[96:99], v[16:19]
    ds_read_b128 v[80:83], v2 offset:18432
    v_mfma_f32_16x16x32_bf16 v[20:23], v[224:227], v[96:99], v[20:23]
    v_mfma_f32_16x16x32_bf16 v[24:27], v[220:223], v[100:103], v[24:27]
    ds_read_b128 v[84:87], v2 offset:18688
    v_mfma_f32_16x16x32_bf16 v[28:31], v[224:227], v[100:103], v[28:31]
    s_waitcnt lgkmcnt(6)
    v_mfma_f32_16x16x32_bf16 v[32:35], v[220:223], v[104:107], v[32:35]
    ds_read_b128 v[88:91], v2 offset:51200
    v_mfma_f32_16x16x32_bf16 v[36:39], v[224:227], v[104:107], v[36:39]
    s_add_u32 s19, s37, 12288
    buffer_load_dwordx4 v[204:207], v1, s[8:11], s19 offen offset:0
    v_mfma_f32_16x16x32_bf16 v[40:43], v[220:223], v[108:111], v[40:43]
    ds_read_b128 v[92:95], v2 offset:51456
    v_mfma_f32_16x16x32_bf16 v[44:47], v[224:227], v[108:111], v[44:47]
    s_waitcnt lgkmcnt(6)
    v_mfma_f32_16x16x32_bf16 v[48:51], v[220:223], v[112:115], v[48:51]
    ds_read_b128 v[96:99], v3 offset:18432
    v_mfma_f32_16x16x32_bf16 v[52:55], v[224:227], v[112:115], v[52:55]
    v_mfma_f32_16x16x32_bf16 v[56:59], v[220:223], v[116:119], v[56:59]
    ds_read_b128 v[100:103], v3 offset:18688
    v_mfma_f32_16x16x32_bf16 v[60:63], v[224:227], v[116:119], v[60:63]
    s_waitcnt lgkmcnt(6)
    v_mfma_f32_16x16x32_bf16 v[64:67], v[220:223], v[120:123], v[64:67]
    ds_read_b128 v[104:107], v3 offset:51200
    v_mfma_f32_16x16x32_bf16 v[68:71], v[224:227], v[120:123], v[68:71]
    s_add_u32 s19, s37, 12288
    buffer_load_dwordx4 v[208:211], v1, s[8:11], s19 offen offset:1024
    v_mfma_f32_16x16x32_bf16 v[72:75], v[220:223], v[4:7], v[72:75]
    ds_read_b128 v[108:111], v3 offset:51456
    v_mfma_f32_16x16x32_bf16 v[76:79], v[224:227], v[4:7], v[76:79]
    s_waitcnt lgkmcnt(6)
    v_mfma_f32_16x16x32_bf16 v[16:19], v[228:231], v[80:83], v[16:19]
    ds_read_b128 v[112:115], v2 offset:20480
    v_mfma_f32_16x16x32_bf16 v[20:23], v[232:235], v[80:83], v[20:23]
    v_mfma_f32_16x16x32_bf16 v[24:27], v[228:231], v[84:87], v[24:27]
    ds_read_b128 v[116:119], v2 offset:20736
    v_mfma_f32_16x16x32_bf16 v[28:31], v[232:235], v[84:87], v[28:31]
    s_waitcnt lgkmcnt(6)
    v_mfma_f32_16x16x32_bf16 v[32:35], v[228:231], v[88:91], v[32:35]
    ds_read_b128 v[120:123], v2 offset:53248
    v_mfma_f32_16x16x32_bf16 v[36:39], v[232:235], v[88:91], v[36:39]
    s_add_u32 s19, s37, 12288
    buffer_load_dwordx4 v[212:215], v1, s[8:11], s19 offen offset:2048
    v_mfma_f32_16x16x32_bf16 v[40:43], v[228:231], v[92:95], v[40:43]
    ds_read_b128 v[4:7], v2 offset:53504
    v_mfma_f32_16x16x32_bf16 v[44:47], v[232:235], v[92:95], v[44:47]
    s_waitcnt lgkmcnt(6)
    v_mfma_f32_16x16x32_bf16 v[48:51], v[228:231], v[96:99], v[48:51]
    ds_read_b128 v[80:83], v3 offset:20480
    v_mfma_f32_16x16x32_bf16 v[52:55], v[232:235], v[96:99], v[52:55]
    v_mfma_f32_16x16x32_bf16 v[56:59], v[228:231], v[100:103], v[56:59]
    ds_read_b128 v[84:87], v3 offset:20736
    v_mfma_f32_16x16x32_bf16 v[60:63], v[232:235], v[100:103], v[60:63]
    s_waitcnt lgkmcnt(6)
    v_mfma_f32_16x16x32_bf16 v[64:67], v[228:231], v[104:107], v[64:67]
    ds_read_b128 v[88:91], v3 offset:53248
    v_mfma_f32_16x16x32_bf16 v[68:71], v[232:235], v[104:107], v[68:71]
    s_add_u32 s19, s37, 12288
    buffer_load_dwordx4 v[216:219], v1, s[8:11], s19 offen offset:3072
    v_mfma_f32_16x16x32_bf16 v[72:75], v[228:231], v[108:111], v[72:75]
    ds_read_b128 v[92:95], v3 offset:53504
    v_mfma_f32_16x16x32_bf16 v[76:79], v[232:235], v[108:111], v[76:79]
    s_waitcnt lgkmcnt(6)
    v_mfma_f32_16x16x32_bf16 v[16:19], v[236:239], v[112:115], v[16:19]
    ds_read_b128 v[96:99], v2 offset:22528
    v_mfma_f32_16x16x32_bf16 v[20:23], v[240:243], v[112:115], v[20:23]
    v_mfma_f32_16x16x32_bf16 v[24:27], v[236:239], v[116:119], v[24:27]
    ds_read_b128 v[100:103], v2 offset:22784
    v_mfma_f32_16x16x32_bf16 v[28:31], v[240:243], v[116:119], v[28:31]
    s_waitcnt lgkmcnt(6)
    v_mfma_f32_16x16x32_bf16 v[32:35], v[236:239], v[120:123], v[32:35]
    ds_read_b128 v[104:107], v2 offset:55296
    v_mfma_f32_16x16x32_bf16 v[36:39], v[240:243], v[120:123], v[36:39]
    s_add_u32 s19, s37, 16384
    buffer_load_dwordx4 v[220:223], v1, s[8:11], s19 offen offset:0
    v_mfma_f32_16x16x32_bf16 v[40:43], v[236:239], v[4:7], v[40:43]
    ds_read_b128 v[108:111], v2 offset:55552
    v_mfma_f32_16x16x32_bf16 v[44:47], v[240:243], v[4:7], v[44:47]
    s_waitcnt lgkmcnt(6)
    v_mfma_f32_16x16x32_bf16 v[48:51], v[236:239], v[80:83], v[48:51]
    ds_read_b128 v[112:115], v3 offset:22528
    v_mfma_f32_16x16x32_bf16 v[52:55], v[240:243], v[80:83], v[52:55]
    v_mfma_f32_16x16x32_bf16 v[56:59], v[236:239], v[84:87], v[56:59]
    ds_read_b128 v[116:119], v3 offset:22784
    v_mfma_f32_16x16x32_bf16 v[60:63], v[240:243], v[84:87], v[60:63]
    s_waitcnt lgkmcnt(6)
    v_mfma_f32_16x16x32_bf16 v[64:67], v[236:239], v[88:91], v[64:67]
    ds_read_b128 v[120:123], v3 offset:55296
    v_mfma_f32_16x16x32_bf16 v[68:71], v[240:243], v[88:91], v[68:71]
    s_add_u32 s19, s37, 16384
    buffer_load_dwordx4 v[224:227], v1, s[8:11], s19 offen offset:1024
    v_mfma_f32_16x16x32_bf16 v[72:75], v[236:239], v[92:95], v[72:75]
    ds_read_b128 v[4:7], v3 offset:55552
    v_mfma_f32_16x16x32_bf16 v[76:79], v[240:243], v[92:95], v[76:79]
    s_waitcnt lgkmcnt(6)
    v_mfma_f32_16x16x32_bf16 v[16:19], v[244:247], v[96:99], v[16:19]
    ds_read_b128 v[80:83], v2 offset:24576
    v_mfma_f32_16x16x32_bf16 v[20:23], v[248:251], v[96:99], v[20:23]
    v_mfma_f32_16x16x32_bf16 v[24:27], v[244:247], v[100:103], v[24:27]
    ds_read_b128 v[84:87], v2 offset:24832
    v_mfma_f32_16x16x32_bf16 v[28:31], v[248:251], v[100:103], v[28:31]
    s_waitcnt lgkmcnt(6)
    v_mfma_f32_16x16x32_bf16 v[32:35], v[244:247], v[104:107], v[32:35]
    ds_read_b128 v[88:91], v2 offset:57344
    v_mfma_f32_16x16x32_bf16 v[36:39], v[248:251], v[104:107], v[36:39]
    s_add_u32 s19, s37, 16384
    buffer_load_dwordx4 v[228:231], v1, s[8:11], s19 offen offset:2048
    v_mfma_f32_16x16x32_bf16 v[40:43], v[244:247], v[108:111], v[40:43]
    ds_read_b128 v[92:95], v2 offset:57600
    v_mfma_f32_16x16x32_bf16 v[44:47], v[248:251], v[108:111], v[44:47]
    s_waitcnt lgkmcnt(6)
    v_mfma_f32_16x16x32_bf16 v[48:51], v[244:247], v[112:115], v[48:51]
    ds_read_b128 v[96:99], v3 offset:24576
    v_mfma_f32_16x16x32_bf16 v[52:55], v[248:251], v[112:115], v[52:55]
    v_mfma_f32_16x16x32_bf16 v[56:59], v[244:247], v[116:119], v[56:59]
    ds_read_b128 v[100:103], v3 offset:24832
    v_mfma_f32_16x16x32_bf16 v[60:63], v[248:251], v[116:119], v[60:63]
    s_waitcnt lgkmcnt(6)
    v_mfma_f32_16x16x32_bf16 v[64:67], v[244:247], v[120:123], v[64:67]
    ds_read_b128 v[104:107], v3 offset:57344
    v_mfma_f32_16x16x32_bf16 v[68:71], v[248:251], v[120:123], v[68:71]
    s_add_u32 s19, s37, 16384
    buffer_load_dwordx4 v[232:235], v1, s[8:11], s19 offen offset:3072
    v_mfma_f32_16x16x32_bf16 v[72:75], v[244:247], v[4:7], v[72:75]
    ds_read_b128 v[108:111], v3 offset:57600
    v_mfma_f32_16x16x32_bf16 v[76:79], v[248:251], v[4:7], v[76:79]
    s_waitcnt lgkmcnt(6)
    v_mfma_f32_16x16x32_bf16 v[16:19], v[124:127], v[80:83], v[16:19]
    ds_read_b128 v[112:115], v2 offset:26624
    v_mfma_f32_16x16x32_bf16 v[20:23], v[128:131], v[80:83], v[20:23]
    v_mfma_f32_16x16x32_bf16 v[24:27], v[124:127], v[84:87], v[24:27]
    ds_read_b128 v[116:119], v2 offset:26880
    v_mfma_f32_16x16x32_bf16 v[28:31], v[128:131], v[84:87], v[28:31]
    s_waitcnt lgkmcnt(6)
    v_mfma_f32_16x16x32_bf16 v[32:35], v[124:127], v[88:91], v[32:35]
    ds_read_b128 v[120:123], v2 offset:59392
    v_mfma_f32_16x16x32_bf16 v[36:39], v[128:131], v[88:91], v[36:39]
    s_add_u32 s19, s37, 20480
    buffer_load_dwordx4 v[236:239], v1, s[8:11], s19 offen offset:0
    v_mfma_f32_16x16x32_bf16 v[40:43], v[124:127], v[92:95], v[40:43]
    ds_read_b128 v[4:7], v2 offset:59648
    v_mfma_f32_16x16x32_bf16 v[44:47], v[128:131], v[92:95], v[44:47]
    s_waitcnt lgkmcnt(6)
    v_mfma_f32_16x16x32_bf16 v[48:51], v[124:127], v[96:99], v[48:51]
    ds_read_b128 v[80:83], v3 offset:26624
    v_mfma_f32_16x16x32_bf16 v[52:55], v[128:131], v[96:99], v[52:55]
    v_mfma_f32_16x16x32_bf16 v[56:59], v[124:127], v[100:103], v[56:59]
    ds_read_b128 v[84:87], v3 offset:26880
    v_mfma_f32_16x16x32_bf16 v[60:63], v[128:131], v[100:103], v[60:63]
    s_waitcnt lgkmcnt(6)
    v_mfma_f32_16x16x32_bf16 v[64:67], v[124:127], v[104:107], v[64:67]
    ds_read_b128 v[88:91], v3 offset:59392
    v_mfma_f32_16x16x32_bf16 v[68:71], v[128:131], v[104:107], v[68:71]
    s_add_u32 s19, s37, 20480
    buffer_load_dwordx4 v[240:243], v1, s[8:11], s19 offen offset:1024
    v_mfma_f32_16x16x32_bf16 v[72:75], v[124:127], v[108:111], v[72:75]
    ds_read_b128 v[92:95], v3 offset:59648
    v_mfma_f32_16x16x32_bf16 v[76:79], v[128:131], v[108:111], v[76:79]
    s_barrier
    s_waitcnt lgkmcnt(6)
    v_mfma_f32_16x16x32_bf16 v[16:19], v[132:135], v[112:115], v[16:19]
    ds_read_b128 v[96:99], v2 offset:28672
    v_mfma_f32_16x16x32_bf16 v[20:23], v[136:139], v[112:115], v[20:23]
    v_mfma_f32_16x16x32_bf16 v[24:27], v[132:135], v[116:119], v[24:27]
    ds_read_b128 v[100:103], v2 offset:28928
    v_mfma_f32_16x16x32_bf16 v[28:31], v[136:139], v[116:119], v[28:31]
    s_waitcnt lgkmcnt(6)
    v_mfma_f32_16x16x32_bf16 v[32:35], v[132:135], v[120:123], v[32:35]
    ds_read_b128 v[104:107], v2 offset:61440
    v_mfma_f32_16x16x32_bf16 v[36:39], v[136:139], v[120:123], v[36:39]
    s_add_u32 s19, s37, 20480
    buffer_load_dwordx4 v[244:247], v1, s[8:11], s19 offen offset:2048
    v_mfma_f32_16x16x32_bf16 v[40:43], v[132:135], v[4:7], v[40:43]
    ds_read_b128 v[108:111], v2 offset:61696
    v_mfma_f32_16x16x32_bf16 v[44:47], v[136:139], v[4:7], v[44:47]
    s_waitcnt lgkmcnt(6)
    v_mfma_f32_16x16x32_bf16 v[48:51], v[132:135], v[80:83], v[48:51]
    ds_read_b128 v[112:115], v3 offset:28672
    v_mfma_f32_16x16x32_bf16 v[52:55], v[136:139], v[80:83], v[52:55]
    v_mfma_f32_16x16x32_bf16 v[56:59], v[132:135], v[84:87], v[56:59]
    ds_read_b128 v[116:119], v3 offset:28928
    v_mfma_f32_16x16x32_bf16 v[60:63], v[136:139], v[84:87], v[60:63]
    s_waitcnt lgkmcnt(6)
    v_mfma_f32_16x16x32_bf16 v[64:67], v[132:135], v[88:91], v[64:67]
    ds_read_b128 v[120:123], v3 offset:61440
    v_mfma_f32_16x16x32_bf16 v[68:71], v[136:139], v[88:91], v[68:71]
    s_add_u32 s19, s37, 20480
    buffer_load_dwordx4 v[248:251], v1, s[8:11], s19 offen offset:3072
    v_mfma_f32_16x16x32_bf16 v[72:75], v[132:135], v[92:95], v[72:75]
    ds_read_b128 v[4:7], v3 offset:61696
    v_mfma_f32_16x16x32_bf16 v[76:79], v[136:139], v[92:95], v[76:79]
    s_waitcnt lgkmcnt(6)
    v_mfma_f32_16x16x32_bf16 v[16:19], v[140:143], v[96:99], v[16:19]
    ds_read_b128 v[80:83], v2 offset:30720
    v_mfma_f32_16x16x32_bf16 v[20:23], v[144:147], v[96:99], v[20:23]
    v_mfma_f32_16x16x32_bf16 v[24:27], v[140:143], v[100:103], v[24:27]
    ds_read_b128 v[84:87], v2 offset:30976
    v_mfma_f32_16x16x32_bf16 v[28:31], v[144:147], v[100:103], v[28:31]
    s_waitcnt lgkmcnt(6)
    v_mfma_f32_16x16x32_bf16 v[32:35], v[140:143], v[104:107], v[32:35]
    ds_read_b128 v[88:91], v2 offset:63488
    v_mfma_f32_16x16x32_bf16 v[36:39], v[144:147], v[104:107], v[36:39]
    s_add_u32 s19, s37, 24576
    buffer_load_dwordx4 v[124:127], v1, s[8:11], s19 offen offset:0
    v_mfma_f32_16x16x32_bf16 v[40:43], v[140:143], v[108:111], v[40:43]
    ds_read_b128 v[92:95], v2 offset:63744
    v_mfma_f32_16x16x32_bf16 v[44:47], v[144:147], v[108:111], v[44:47]
    s_waitcnt lgkmcnt(6)
    v_mfma_f32_16x16x32_bf16 v[48:51], v[140:143], v[112:115], v[48:51]
    ds_read_b128 v[96:99], v3 offset:30720
    v_mfma_f32_16x16x32_bf16 v[52:55], v[144:147], v[112:115], v[52:55]
    v_mfma_f32_16x16x32_bf16 v[56:59], v[140:143], v[116:119], v[56:59]
    ds_read_b128 v[100:103], v3 offset:30976
    v_mfma_f32_16x16x32_bf16 v[60:63], v[144:147], v[116:119], v[60:63]
    s_waitcnt lgkmcnt(6)
    v_mfma_f32_16x16x32_bf16 v[64:67], v[140:143], v[120:123], v[64:67]
    ds_read_b128 v[104:107], v3 offset:63488
    v_mfma_f32_16x16x32_bf16 v[68:71], v[144:147], v[120:123], v[68:71]
    s_add_u32 s19, s37, 24576
    buffer_load_dwordx4 v[128:131], v1, s[8:11], s19 offen offset:1024
    v_mfma_f32_16x16x32_bf16 v[72:75], v[140:143], v[4:7], v[72:75]
    ds_read_b128 v[108:111], v3 offset:63744
    v_mfma_f32_16x16x32_bf16 v[76:79], v[144:147], v[4:7], v[76:79]
    s_waitcnt lgkmcnt(6)
    v_mfma_f32_16x16x32_bf16 v[16:19], v[148:151], v[80:83], v[16:19]
    v_mfma_f32_16x16x32_bf16 v[20:23], v[152:155], v[80:83], v[20:23]
    v_mfma_f32_16x16x32_bf16 v[24:27], v[148:151], v[84:87], v[24:27]
    v_mfma_f32_16x16x32_bf16 v[28:31], v[152:155], v[84:87], v[28:31]
    s_waitcnt lgkmcnt(4)
    v_mfma_f32_16x16x32_bf16 v[32:35], v[148:151], v[88:91], v[32:35]
    v_mfma_f32_16x16x32_bf16 v[36:39], v[152:155], v[88:91], v[36:39]
    ds_read_b128 v[112:115], v12
    ds_read_b128 v[116:119], v12 offset:64
    ds_read_b128 v[120:123], v11 offset:0
    ds_read_b128 v[4:7], v11 offset:256
    s_add_u32 s19, s37, 24576
    buffer_load_dwordx4 v[132:135], v1, s[8:11], s19 offen offset:2048
    v_mfma_f32_16x16x32_bf16 v[40:43], v[148:151], v[92:95], v[40:43]
    v_mfma_f32_16x16x32_bf16 v[44:47], v[152:155], v[92:95], v[44:47]
    s_waitcnt lgkmcnt(6)
    v_mfma_f32_16x16x32_bf16 v[48:51], v[148:151], v[96:99], v[48:51]
    v_mfma_f32_16x16x32_bf16 v[52:55], v[152:155], v[96:99], v[52:55]
    v_mfma_f32_16x16x32_bf16 v[56:59], v[148:151], v[100:103], v[56:59]
    v_mfma_f32_16x16x32_bf16 v[60:63], v[152:155], v[100:103], v[60:63]
    s_waitcnt lgkmcnt(4)
    v_mfma_f32_16x16x32_bf16 v[64:67], v[148:151], v[104:107], v[64:67]
    v_mfma_f32_16x16x32_bf16 v[68:71], v[152:155], v[104:107], v[68:71]
    s_add_u32 s19, s37, 24576
    buffer_load_dwordx4 v[136:139], v1, s[8:11], s19 offen offset:3072
    v_mfma_f32_16x16x32_bf16 v[72:75], v[148:151], v[108:111], v[72:75]
    v_mfma_f32_16x16x32_bf16 v[76:79], v[152:155], v[108:111], v[76:79]
    ds_read_b128 v[80:83], v11 offset:512
    ds_read_b128 v[84:87], v11 offset:768
    ds_read_b128 v[88:91], v11 offset:1024
    ds_read_b128 v[92:95], v11 offset:1280
    ds_read_b128 v[96:99], v11 offset:1536
    ds_read_b128 v[100:103], v11 offset:1792
    s_waitcnt lgkmcnt(6)
    v_pk_fma_f32 v[16:17], v[112:113], v[120:121], v[16:17] neg_lo:[0,1,0] neg_hi:[0,1,0]
    v_pk_fma_f32 v[18:19], v[114:115], v[120:121], v[18:19] neg_lo:[0,1,0] neg_hi:[0,1,0]
    v_pk_fma_f32 v[20:21], v[116:117], v[120:121], v[20:21] neg_lo:[0,1,0] neg_hi:[0,1,0]
    v_pk_fma_f32 v[22:23], v[118:119], v[120:121], v[22:23] neg_lo:[0,1,0] neg_hi:[0,1,0]
    v_pk_mul_f32 v[16:17], v[16:17], v[122:123]
    v_pk_mul_f32 v[18:19], v[18:19], v[122:123]
    v_pk_mul_f32 v[16:17], v[16:17], v[20:21]
    v_pk_mul_f32 v[18:19], v[18:19], v[22:23]
    v_pk_fma_f32 v[24:25], v[112:113], v[4:5], v[24:25] neg_lo:[0,1,0] neg_hi:[0,1,0]
    v_pk_fma_f32 v[26:27], v[114:115], v[4:5], v[26:27] neg_lo:[0,1,0] neg_hi:[0,1,0]
    v_pk_fma_f32 v[28:29], v[116:117], v[4:5], v[28:29] neg_lo:[0,1,0] neg_hi:[0,1,0]
    v_pk_fma_f32 v[30:31], v[118:119], v[4:5], v[30:31] neg_lo:[0,1,0] neg_hi:[0,1,0]
    v_pk_mul_f32 v[24:25], v[24:25], v[6:7]
    v_pk_mul_f32 v[26:27], v[26:27], v[6:7]
    v_pk_mul_f32 v[24:25], v[24:25], v[28:29]
    v_pk_mul_f32 v[26:27], v[26:27], v[30:31]
    v_cvt_pk_bf16_f32 v20, v16, v17
    v_cvt_pk_bf16_f32 v21, v18, v19
    v_cvt_pk_bf16_f32 v22, v24, v25
    v_cvt_pk_bf16_f32 v23, v26, v27
    s_nop 0
    v_permlane32_swap_b32 v20, v22
    v_permlane32_swap_b32 v21, v23
    s_cmp_eq_u32 s29, 0
    s_cbranch_scc1 ST_slow_25
    buffer_store_dwordx4 v[20:23], v14, s[8:11], s58 offen offset:0
ST_done_26:
    s_waitcnt lgkmcnt(4)
    v_pk_fma_f32 v[32:33], v[112:113], v[80:81], v[32:33] neg_lo:[0,1,0] neg_hi:[0,1,0]
    v_pk_fma_f32 v[34:35], v[114:115], v[80:81], v[34:35] neg_lo:[0,1,0] neg_hi:[0,1,0]
    v_pk_fma_f32 v[36:37], v[116:117], v[80:81], v[36:37] neg_lo:[0,1,0] neg_hi:[0,1,0]
    v_pk_fma_f32 v[38:39], v[118:119], v[80:81], v[38:39] neg_lo:[0,1,0] neg_hi:[0,1,0]
    v_pk_mul_f32 v[32:33], v[32:33], v[82:83]
    v_pk_mul_f32 v[34:35], v[34:35], v[82:83]
    v_pk_mul_f32 v[32:33], v[32:33], v[36:37]
    v_pk_mul_f32 v[34:35], v[34:35], v[38:39]
    v_pk_fma_f32 v[40:41], v[112:113], v[84:85], v[40:41] neg_lo:[0,1,0] neg_hi:[0,1,0]
    v_pk_fma_f32 v[42:43], v[114:115], v[84:85], v[42:43] neg_lo:[0,1,0] neg_hi:[0,1,0]
    v_pk_fma_f32 v[44:45], v[116:117], v[84:85], v[44:45] neg_lo:[0,1,0] neg_hi:[0,1,0]
    v_pk_fma_f32 v[46:47], v[118:119], v[84:85], v[46:47] neg_lo:[0,1,0] neg_hi:[0,1,0]
    v_pk_mul_f32 v[40:41], v[40:41], v[86:87]
    v_pk_mul_f32 v[42:43], v[42:43], v[86:87]
    v_pk_mul_f32 v[40:41], v[40:41], v[44:45]
    v_pk_mul_f32 v[42:43], v[42:43], v[46:47]
    v_cvt_pk_bf16_f32 v36, v32, v33
    v_cvt_pk_bf16_f32 v37, v34, v35
    v_cvt_pk_bf16_f32 v38, v40, v41
    v_cvt_pk_bf16_f32 v39, v42, v43
    s_nop 0
    v_permlane32_swap_b32 v36, v38
    v_permlane32_swap_b32 v37, v39
    s_cmp_eq_u32 s29, 0
    s_cbranch_scc1 ST_slow_27
    buffer_store_dwordx4 v[36:39], v14, s[8:11], s58 offen offset:1024
ST_done_28:
    s_waitcnt lgkmcnt(2)
    v_pk_fma_f32 v[48:49], v[112:113], v[88:89], v[48:49] neg_lo:[0,1,0] neg_hi:[0,1,0]
    v_pk_fma_f32 v[50:51], v[114:115], v[88:89], v[50:51] neg_lo:[0,1,0] neg_hi:[0,1,0]
    v_pk_fma_f32 v[52:53], v[116:117], v[88:89], v[52:53] neg_lo:[0,1,0] neg_hi:[0,1,0]
    v_pk_fma_f32 v[54:55], v[118:119], v[88:89], v[54:55] neg_lo:[0,1,0] neg_hi:[0,1,0]
    v_pk_mul_f32 v[48:49], v[48:49], v[90:91]
    v_pk_mul_f32 v[50:51], v[50:51], v[90:91]
    v_pk_mul_f32 v[48:49], v[48:49], v[52:53]
    v_pk_mul_f32 v[50:51], v[50:51], v[54:55]
    v_pk_fma_f32 v[56:57], v[112:113], v[92:93], v[56:57] neg_lo:[0,1,0] neg_hi:[0,1,0]
    v_pk_fma_f32 v[58:59], v[114:115], v[92:93], v[58:59] neg_lo:[0,1,0] neg_hi:[0,1,0]
    v_pk_fma_f32 v[60:61], v[116:117], v[92:93], v[60:61] neg_lo:[0,1,0] neg_hi:[0,1,0]
    v_pk_fma_f32 v[62:63], v[118:119], v[92:93], v[62:63] neg_lo:[0,1,0] neg_hi:[0,1,0]
    v_pk_mul_f32 v[56:57], v[56:57], v[94:95]
    v_pk_mul_f32 v[58:59], v[58:59], v[94:95]
    v_pk_mul_f32 v[56:57], v[56:57], v[60:61]
    v_pk_mul_f32 v[58:59], v[58:59], v[62:63]
    v_cvt_pk_bf16_f32 v52, v48, v49
    v_cvt_pk_bf16_f32 v53, v50, v51
    v_cvt_pk_bf16_f32 v54, v56, v57
    v_cvt_pk_bf16_f32 v55, v58, v59
    s_nop 0
    v_permlane32_swap_b32 v52, v54
    v_permlane32_swap_b32 v53, v55
    s_cmp_eq_u32 s29, 0
    s_cbranch_scc1 ST_slow_29
    buffer_store_dwordx4 v[52:55], v14, s[8:11], s14 offen offset:0
ST_done_30:
    s_waitcnt lgkmcnt(0)
    v_pk_fma_f32 v[64:65], v[112:113], v[96:97], v[64:65] neg_lo:[0,1,0] neg_hi:[0,1,0]
    v_pk_fma_f32 v[66:67], v[114:115], v[96:97], v[66:67] neg_lo:[0,1,0] neg_hi:[0,1,0]
    v_pk_fma_f32 v[68:69], v[116:117], v[96:97], v[68:69] neg_lo:[0,1,0] neg_hi:[0,1,0]
    v_pk_fma_f32 v[70:71], v[118:119], v[96:97], v[70:71] neg_lo:[0,1,0] neg_hi:[0,1,0]
    v_pk_mul_f32 v[64:65], v[64:65], v[98:99]
    v_pk_mul_f32 v[66:67], v[66:67], v[98:99]
    v_pk_mul_f32 v[64:65], v[64:65], v[68:69]
    v_pk_mul_f32 v[66:67], v[66:67], v[70:71]
    v_pk_fma_f32 v[72:73], v[112:113], v[100:101], v[72:73] neg_lo:[0,1,0] neg_hi:[0,1,0]
    v_pk_fma_f32 v[74:75], v[114:115], v[100:101], v[74:75] neg_lo:[0,1,0] neg_hi:[0,1,0]
    v_pk_fma_f32 v[76:77], v[116:117], v[100:101], v[76:77] neg_lo:[0,1,0] neg_hi:[0,1,0]
    v_pk_fma_f32 v[78:79], v[118:119], v[100:101], v[78:79] neg_lo:[0,1,0] neg_hi:[0,1,0]
    v_pk_mul_f32 v[72:73], v[72:73], v[102:103]
    v_pk_mul_f32 v[74:75], v[74:75], v[102:103]
    v_pk_mul_f32 v[72:73], v[72:73], v[76:77]
    v_pk_mul_f32 v[74:75], v[74:75], v[78:79]
    v_cvt_pk_bf16_f32 v68, v64, v65
    v_cvt_pk_bf16_f32 v69, v66, v67
    v_cvt_pk_bf16_f32 v70, v72, v73
    v_cvt_pk_bf16_f32 v71, v74, v75
    s_nop 0
    v_permlane32_swap_b32 v68, v70
    v_permlane32_swap_b32 v69, v71
    s_cmp_eq_u32 s29, 0
    s_cbranch_scc1 ST_slow_31
    buffer_store_dwordx4 v[68:71], v14, s[8:11], s14 offen offset:1024
ST_done_32:
GU_end:
    s_add_u32 s32, s32, 1
    s_waitcnt vmcnt(0)
    s_barrier
    s_cmp_lg_u32 s3, 0
    s_cbranch_scc1 SIG_33
    v_mov_b32 v2, s32
    v_mov_b32 v3, 0
    s_mov_b64 exec, 1
    s_cmp_eq_u32 s29, 0
    s_cbranch_scc1 ST_slow_34
    buffer_store_dword v2, v3, s[8:11], s30 offen
ST_done_35:
    s_mov_b64 exec, -1
SIG_33:
    s_lshr_b32 s12, s28, 3
    s_mul_i32 s17, s12, 229376
    s_mul_i32 s14, s3, 28672
    s_add_u32 s17, s17, s14
    s_add_u32 s17, s17, s35
    s_add_u32 s17, s17, 8388608
    s_add_u32 s20, s61, 20971520
    v_lshlrev_b32 v8, 16, v252
    v_and_b32 v9, 0xffff0000, v252
    v_lshlrev_b32 v10, 16, v253
    v_and_b32 v11, 0xffff0000, v253
    v_lshlrev_b32 v12, 16, v254
    v_and_b32 v13, 0xffff0000, v254
    v_lshlrev_b32 v14, 16, v255
    v_and_b32 v15, 0xffff0000, v255
    s_cmp_lg_u32 s3, 7
    s_cbranch_scc1 WAIT_36
    s_and_b32 s18, s30, 0xffffffc0
    v_and_b32 v2, 15, v0
    v_lshlrev_b32 v2, 2, v2
    s_mov_b32 s19, 0
POLL_37:
    buffer_load_dword v3, v2, s[8:11], s18 offen sc1
    s_add_u32 s19, s19, 1
    s_waitcnt vmcnt(0)
    v_cmp_gt_u32 vcc, s32, v3
    s_cmp_gt_u32 s19, 200000
    s_cbranch_scc1 POLLE_38
    s_cbranch_vccnz POLL_37
POLLE_38:
WAIT_36:
    s_barrier
    buffer_load_dwordx4 v[80:83], v1, s[8:11], s17 offen offset:0 sc1
    buffer_load_dwordx4 v[84:87], v1, s[8:11], s17 offen offset:1024 sc1
    buffer_load_dwordx4 v[88:91], v1, s[8:11], s17 offen offset:2048 sc1
    buffer_load_dwordx4 v[92:95], v1, s[8:11], s17 offen offset:3072 sc1
    s_add_u32 s19, s17, 4096
    buffer_load_dwordx4 v[96:99], v1, s[8:11], s19 offen offset:0 sc1
    buffer_load_dwordx4 v[100:103], v1, s[8:11], s19 offen offset:1024 sc1
    s_add_u32 s19, s17, 4096
    buffer_load_dwordx4 v[104:107], v1, s[8:11], s19 offen offset:2048 sc1
    buffer_load_dwordx4 v[108:111], v1, s[8:11], s19 offen offset:3072 sc1
    s_add_u32 s19, s17, 8192
    buffer_load_dwordx4 v[112:115], v1, s[8:11], s19 offen offset:0 sc1
    buffer_load_dwordx4 v[116:119], v1, s[8:11], s19 offen offset:1024 sc1
    s_add_u32 s19, s17, 8192
    buffer_load_dwordx4 v[140:143], v1, s[8:11], s19 offen offset:2048 sc1
    buffer_load_dwordx4 v[144:147], v1, s[8:11], s19 offen offset:3072 sc1
    s_add_u32 s19, s17, 12288
    buffer_load_dwordx4 v[148:151], v1, s[8:11], s19 offen offset:0 sc1
    buffer_load_dwordx4 v[152:155], v1, s[8:11], s19 offen offset:1024 sc1
    s_waitcnt vmcnt(12)
    v_mfma_f32_32x32x16_bf16 v[16:31], v[156:159], v[80:83], 0
    v_mfma_f32_32x32x16_bf16 v[32:47], v[160:163], v[80:83], 0
    v_mfma_f32_32x32x16_bf16 v[48:63], v[156:159], v[84:87], 0
    v_mfma_f32_32x32x16_bf16 v[64:79], v[160:163], v[84:87], 0
    s_add_u32 s19, s17, 12288
    buffer_load_dwordx4 v[80:83], v1, s[8:11], s19 offen offset:2048 sc1
    buffer_load_dwordx4 v[84:87], v1, s[8:11], s19 offen offset:3072 sc1
    s_waitcnt vmcnt(12)
    v_mfma_f32_32x32x16_bf16 v[16:31], v[164:167], v[88:91], v[16:31]
    v_mfma_f32_32x32x16_bf16 v[32:47], v[168:171], v[88:91], v[32:47]
    v_mfma_f32_32x32x16_bf16 v[48:63], v[164:167], v[92:95], v[48:63]
    v_mfma_f32_32x32x16_bf16 v[64:79], v[168:171], v[92:95], v[64:79]
    s_add_u32 s19, s17, 16384
    buffer_load_dwordx4 v[88:91], v1, s[8:11], s19 offen offset:0 sc1
    buffer_load_dwordx4 v[92:95], v1, s[8:11], s19 offen offset:1024 sc1
    s_waitcnt vmcnt(12)
    v_mfma_f32_32x32x16_bf16 v[16:31], v[172:175], v[96:99], v[16:31]
    v_mfma_f32_32x32x16_bf16 v[32:47], v[176:179], v[96:99], v[32:47]
    v_mfma_f32_32x32x16_bf16 v[48:63], v[172:175], v[100:103], v[48:63]
    v_mfma_f32_32x32x16_bf16 v[64:79], v[176:179], v[100:103], v[64:79]
    s_add_u32 s19, s17, 16384
    buffer_load_dwordx4 v[96:99], v1, s[8:11], s19 offen offset:2048 sc1
    buffer_load_dwordx4 v[100:103], v1, s[8:11], s19 offen offset:3072 sc1
    s_waitcnt vmcnt(12)
    v_mfma_f32_32x32x16_bf16 v[16:31], v[180:183], v[104:107], v[16:31]
    v_mfma_f32_32x32x16_bf16 v[32:47], v[184:187], v[104:107], v[32:47]
    v_mfma_f32_32x32x16_bf16 v[48:63], v[180:183], v[108:111], v[48:63]
    v_mfma_f32_32x32x16_bf16 v[64:79], v[184:187], v[108:111], v[64:79]
    s_add_u32 s19, s17, 20480
    buffer_load_dwordx4 v[104:107], v1, s[8:11], s19 offen offset:0 sc1
    buffer_load_dwordx4 v[108:111], v1, s[8:11], s19 offen offset:1024 sc1
    s_waitcnt vmcnt(12)
    v_mfma_f32_32x32x16_bf16 v[16:31], v[188:191], v[112:115], v[16:31]
    v_mfma_f32_32x32x16_bf16 v[32:47], v[192:195], v[112:115], v[32:47]
    v_mfma_f32_32x32x16_bf16 v[48:63], v[188:191], v[116:119], v[48:63]
    v_mfma_f32_32x32x16_bf16 v[64:79], v[192:195], v[116:119], v[64:79]
    s_add_u32 s19, s17, 20480
    buffer_load_dwordx4 v[112:115], v1, s[8:11], s19 offen offset:2048 sc1
    buffer_load_dwordx4 v[116:119], v1, s[8:11], s19 offen offset:3072 sc1
    s_waitcnt vmcnt(12)
    v_mfma_f32_32x32x16_bf16 v[16:31], v[196:199], v[140:143], v[16:31]
    v_mfma_f32_32x32x16_bf16 v[32:47], v[200:203], v[140:143], v[32:47]
    v_mfma_f32_32x32x16_bf16 v[48:63], v[196:199], v[144:147], v[48:63]
    v_mfma_f32_32x32x16_bf16 v[64:79], v[200:203], v[144:147], v[64:79]
    s_add_u32 s19, s17, 24576
    buffer_load_dwordx4 v[140:143], v1, s[8:11], s19 offen offset:0 sc1
    buffer_load_dwordx4 v[144:147], v1, s[8:11], s19 offen offset:1024 sc1
    s_waitcnt vmcnt(12)
    v_mfma_f32_32x32x16_bf16 v[16:31], v[204:207], v[148:151], v[16:31]
    v_mfma_f32_32x32x16_bf16 v[32:47], v[208:211], v[148:151], v[32:47]
    v_mfma_f32_32x32x16_bf16 v[48:63], v[204:207], v[152:155], v[48:63]
    v_mfma_f32_32x32x16_bf16 v[64:79], v[208:211], v[152:155], v[64:79]
    s_add_u32 s19, s17, 24576
    buffer_load_dwordx4 v[148:151], v1, s[8:11], s19 offen offset:2048 sc1
    buffer_load_dwordx4 v[152:155], v1, s[8:11], s19 offen offset:3072 sc1
    s_waitcnt vmcnt(12)
    v_mfma_f32_32x32x16_bf16 v[16:31], v[212:215], v[80:83], v[16:31]
    v_mfma_f32_32x32x16_bf16 v[32:47], v[216:219], v[80:83], v[32:47]
    v_mfma_f32_32x32x16_bf16 v[48:63], v[212:215], v[84:87], v[48:63]
    v_mfma_f32_32x32x16_bf16 v[64:79], v[216:219], v[84:87], v[64:79]
    s_waitcnt vmcnt(10)
    v_mfma_f32_32x32x16_bf16 v[16:31], v[220:223], v[88:91], v[16:31]
    v_mfma_f32_32x32x16_bf16 v[32:47], v[224:227], v[88:91], v[32:47]
    v_mfma_f32_32x32x16_bf16 v[48:63], v[220:223], v[92:95], v[48:63]
    v_mfma_f32_32x32x16_bf16 v[64:79], v[224:227], v[92:95], v[64:79]
    s_waitcnt vmcnt(8)
    v_mfma_f32_32x32x16_bf16 v[16:31], v[228:231], v[96:99], v[16:31]
    v_mfma_f32_32x32x16_bf16 v[32:47], v[232:235], v[96:99], v[32:47]
    v_mfma_f32_32x32x16_bf16 v[48:63], v[228:231], v[100:103], v[48:63]
    v_mfma_f32_32x32x16_bf16 v[64:79], v[232:235], v[100:103], v[64:79]
    s_waitcnt vmcnt(6)
    v_mfma_f32_32x32x16_bf16 v[16:31], v[236:239], v[104:107], v[16:31]
    v_mfma_f32_32x32x16_bf16 v[32:47], v[240:243], v[104:107], v[32:47]
    v_mfma_f32_32x32x16_bf16 v[48:63], v[236:239], v[108:111], v[48:63]
    v_mfma_f32_32x32x16_bf16 v[64:79], v[240:243], v[108:111], v[64:79]
    s_waitcnt vmcnt(4)
    v_mfma_f32_32x32x16_bf16 v[16:31], v[244:247], v[112:115], v[16:31]
    v_mfma_f32_32x32x16_bf16 v[32:47], v[248:251], v[112:115], v[32:47]
    v_mfma_f32_32x32x16_bf16 v[48:63], v[244:247], v[116:119], v[48:63]
    v_mfma_f32_32x32x16_bf16 v[64:79], v[248:251], v[116:119], v[64:79]
    s_waitcnt vmcnt(2)
    v_mfma_f32_32x32x16_bf16 v[16:31], v[124:127], v[140:143], v[16:31]
    v_mfma_f32_32x32x16_bf16 v[32:47], v[128:131], v[140:143], v[32:47]
    v_mfma_f32_32x32x16_bf16 v[48:63], v[124:127], v[144:147], v[48:63]
    v_mfma_f32_32x32x16_bf16 v[64:79], v[128:131], v[144:147], v[64:79]
    s_waitcnt vmcnt(0)
    v_mfma_f32_32x32x16_bf16 v[16:31], v[132:135], v[148:151], v[16:31]
    v_mfma_f32_32x32x16_bf16 v[32:47], v[136:139], v[148:151], v[32:47]
    v_mfma_f32_32x32x16_bf16 v[48:63], v[132:135], v[152:155], v[48:63]
    v_mfma_f32_32x32x16_bf16 v[64:79], v[136:139], v[152:155], v[64:79]
    s_lshl_b32 s17, s3, 11
    v_add_u32 v2, s17, v1
    v_add_u32 v3, 65536, v2
    s_nop 5
    ds_write_b128 v2, v[16:19] offset:0
    ds_write_b128 v2, v[20:23] offset:1024
    ds_write_b128 v2, v[24:27] offset:16384
    ds_write_b128 v2, v[28:31] offset:17408
    ds_write_b128 v2, v[32:35] offset:32768
    ds_write_b128 v2, v[36:39] offset:33792
    ds_write_b128 v2, v[40:43] offset:49152
    ds_write_b128 v2, v[44:47] offset:50176
    ds_write_b128 v3, v[48:51] offset:0
    ds_write_b128 v3, v[52:55] offset:1024
    ds_write_b128 v3, v[56:59] offset:16384
    ds_write_b128 v3, v[60:63] offset:17408
    ds_write_b128 v3, v[64:67] offset:32768
    ds_write_b128 v3, v[68:71] offset:33792
    ds_write_b128 v3, v[72:75] offset:49152
    ds_write_b128 v3, v[76:79] offset:50176
    s_lshl_b32 s17, s3, 14
    v_add_u32 v2, s17, v1
    s_waitcnt lgkmcnt(0)
    s_barrier
    ds_read_b128 v[16:19], v2 offset:0
    ds_read_b128 v[20:23], v2 offset:1024
    ds_read_b128 v[24:27], v2 offset:2048
    ds_read_b128 v[28:31], v2 offset:3072
    ds_read_b128 v[32:35], v2 offset:4096
    ds_read_b128 v[36:39], v2 offset:5120
    ds_read_b128 v[40:43], v2 offset:6144
    ds_read_b128 v[44:47], v2 offset:7168
    ds_read_b128 v[48:51], v2 offset:8192
    ds_read_b128 v[52:55], v2 offset:9216
    ds_read_b128 v[56:59], v2 offset:10240
    ds_read_b128 v[60:63], v2 offset:11264
    ds_read_b128 v[64:67], v2 offset:12288
    ds_read_b128 v[68:71], v2 offset:13312
    ds_read_b128 v[72:75], v2 offset:14336
    ds_read_b128 v[76:79], v2 offset:15360
    s_waitcnt lgkmcnt(14)
    v_pk_add_f32 v[8:9], v[8:9], v[16:17]
    v_pk_add_f32 v[10:11], v[10:11], v[18:19]
    v_pk_add_f32 v[12:13], v[12:13], v[20:21]
    v_pk_add_f32 v[14:15], v[14:15], v[22:23]
    s_waitcnt lgkmcnt(12)
    v_pk_add_f32 v[8:9], v[8:9], v[24:25]
    v_pk_add_f32 v[10:11], v[10:11], v[26:27]
    v_pk_add_f32 v[12:13], v[12:13], v[28:29]
    v_pk_add_f32 v[14:15], v[14:15], v[30:31]
    s_waitcnt lgkmcnt(10)
    v_pk_add_f32 v[8:9], v[8:9], v[32:33]
    v_pk_add_f32 v[10:11], v[10:11], v[34:35]
    v_pk_add_f32 v[12:13], v[12:13], v[36:37]
    v_pk_add_f32 v[14:15], v[14:15], v[38:39]
    s_waitcnt lgkmcnt(8)
    v_pk_add_f32 v[8:9], v[8:9], v[40:41]
    v_pk_add_f32 v[10:11], v[10:11], v[42:43]
    v_pk_add_f32 v[12:13], v[12:13], v[44:45]
    v_pk_add_f32 v[14:15], v[14:15], v[46:47]
    s_waitcnt lgkmcnt(6)
    v_pk_add_f32 v[8:9], v[8:9], v[48:49]
    v_pk_add_f32 v[10:11], v[10:11], v[50:51]
    v_pk_add_f32 v[12:13], v[12:13], v[52:53]
    v_pk_add_f32 v[14:15], v[14:15], v[54:55]
    s_waitcnt lgkmcnt(4)
    v_pk_add_f32 v[8:9], v[8:9], v[56:57]
    v_pk_add_f32 v[10:11], v[10:11], v[58:59]
    v_pk_add_f32 v[12:13], v[12:13], v[60:61]
    v_pk_add_f32 v[14:15], v[14:15], v[62:63]
    s_waitcnt lgkmcnt(2)
    v_pk_add_f32 v[8:9], v[8:9], v[64:65]
    v_pk_add_f32 v[10:11], v[10:11], v[66:67]
    v_pk_add_f32 v[12:13], v[12:13], v[68:69]
    v_pk_add_f32 v[14:15], v[14:15], v[70:71]
    s_waitcnt lgkmcnt(0)
    v_pk_add_f32 v[8:9], v[8:9], v[72:73]
    v_pk_add_f32 v[10:11], v[10:11], v[74:75]
    v_pk_add_f32 v[12:13], v[12:13], v[76:77]
    v_pk_add_f32 v[14:15], v[14:15], v[78:79]
    v_cvt_pk_bf16_f32 v4, v8, v9
    v_cvt_pk_bf16_f32 v5, v10, v11
    v_cvt_pk_bf16_f32 v6, v12, v13
    v_cvt_pk_bf16_f32 v7, v14, v15
    v_mov_b32 v252, v4
    v_mov_b32 v253, v5
    v_mov_b32 v254, v6
    v_mov_b32 v255, v7
    v_permlane32_swap_b32 v4, v6
    v_permlane32_swap_b32 v5, v7
    s_cmp_lg_u32 s33, 0
    s_cbranch_scc1 DN_final
    s_cmp_eq_u32 s29, 0
    s_cbranch_scc1 ST_slow_40
    buffer_store_dwordx4 v[4:7], v1, s[8:11], s20 offen
ST_done_41:
    v_mov_b32 v8, 0
    v_mov_b32 v9, 0
    v_mov_b32 v10, 0x3f803f80
    v_lshrrev_b32 v11, 1, v1
    v_dot2c_f32_bf16 v8, v252, v10
    v_dot2c_f32_bf16 v9, v252, v252
    v_dot2c_f32_bf16 v8, v253, v10
    v_dot2c_f32_bf16 v9, v253, v253
    v_dot2c_f32_bf16 v8, v254, v10
    v_dot2c_f32_bf16 v9, v254, v254
    v_dot2c_f32_bf16 v8, v255, v10
    v_dot2c_f32_bf16 v9, v255, v255
    s_lshr_b32 s22, s61, 2
    s_add_u32 s22, s22, 23068672
    v_mov_b32 v12, v8
    v_mov_b32 v13, v9
    s_nop 0
    v_permlane32_swap_b32 v8, v12
    v_permlane32_swap_b32 v9, v13
    v_pk_add_f32 v[8:9], v[8:9], v[12:13]
    s_mov_b32 exec_hi, 0
    s_cmp_eq_u32 s29, 0
    s_cbranch_scc1 ST_slow_42
    buffer_store_dwordx2 v[8:9], v11, s[8:11], s22 offen
ST_done_43:
    s_mov_b32 exec_hi, -1
    s_xor_b32 s21, s39, 0x8000
    s_cmp_eq_u32 s63, 0
    s_cbranch_scc1 DN_wk
    buffer_load_dwordx4 v[156:159], v1, s[8:11], s39 offen offset:0
    buffer_load_dwordx4 v[160:163], v1, s[8:11], s39 offen offset:1024
    buffer_load_dwordx4 v[164:167], v1, s[8:11], s39 offen offset:2048
    buffer_load_dwordx4 v[168:171], v1, s[8:11], s39 offen offset:3072
    s_add_u32 s19, s39, 4096
    buffer_load_dwordx4 v[172:175], v1, s[8:11], s19 offen offset:0
    buffer_load_dwordx4 v[176:179], v1, s[8:11], s19 offen offset:1024
    buffer_load_dwordx4 v[180:183], v1, s[8:11], s19 offen offset:2048
    buffer_load_dwordx4 v[184:187], v1, s[8:11], s19 offen offset:3072
DN_wd:
    s_add_u32 s32, s32, 1
    s_waitcnt vmcnt(8)
    s_barrier
    s_cmp_lg_u32 s3, 0
    s_cbranch_scc1 SIG_44
    v_mov_b32 v2, s32
    v_mov_b32 v3, 0
    s_mov_b64 exec, 1
    s_cmp_eq_u32 s29, 0
    s_cbranch_scc1 ST_slow_45
    buffer_store_dword v2, v3, s[8:11], s30 offen
ST_done_46:
    s_mov_b64 exec, -1
SIG_44:
    s_cmp_lg_u32 s63, 0
    s_cbranch_scc1 DN_nwa
    buffer_load_dwordx4 v[156:159], v1, s[8:11], s39 offen offset:0
    buffer_load_dwordx4 v[160:163], v1, s[8:11], s39 offen offset:1024
    buffer_load_dwordx4 v[164:167], v1, s[8:11], s39 offen offset:2048
    buffer_load_dwordx4 v[168:171], v1, s[8:11], s39 offen offset:3072
    s_add_u32 s19, s39, 4096
    buffer_load_dwordx4 v[172:175], v1, s[8:11], s19 offen offset:0
    buffer_load_dwordx4 v[176:179], v1, s[8:11], s19 offen offset:1024
    buffer_load_dwordx4 v[180:183], v1, s[8:11], s19 offen offset:2048
    buffer_load_dwordx4 v[184:187], v1, s[8:11], s19 offen offset:3072
DN_nwa:
    s_mov_b32 s33, 1
    s_mov_b32 s31, 33554432
    s_add_u32 s53, s53, 16777216
    s_add_u32 s60, s60, 8192
    s_lshr_b32 s14, s3, 2
    s_and_b32 s15, s3, 3
    v_mov_b32 v128, 0x3f803f80
    v_mov_b32 v129, 0x3f803f80
    v_mov_b32 v130, 0x3f803f80
    v_mov_b32 v131, 0x3f803f80
    v_mov_b32 v132, 0
    v_mov_b32 v133, 0
    v_lshrrev_b32 v4, 9, v1
    v_lshlrev_b32 v4, 4, v4
    s_add_u32 s20, s55, 20971520
    s_lshr_b32 s22, s55, 2
    s_add_u32 s22, s22, 23068672
    v_and_b32 v104, 15, v0
    v_lshlrev_b32 v104, 4, v104
    v_lshl_add_u32 v104, v4, 4, v104
    s_lshl_b32 s17, s3, 9
    s_add_u32 s17, s17, 57344
    v_add_u32 v104, s17, v104
    s_cmp_lg_u32 s3, 7
    s_cbranch_scc1 WAIT_47
    s_and_b32 s18, s30, 0xffffffe0
    v_and_b32 v2, 7, v0
    v_lshlrev_b32 v2, 2, v2
    s_mov_b32 s19, 0
POLL_48:
    buffer_load_dword v3, v2, s[8:11], s18 offen sc1
    s_add_u32 s19, s19, 1
    s_waitcnt vmcnt(0)
    v_cmp_gt_u32 vcc, s32, v3
    s_cmp_gt_u32 s19, 200000
    s_cbranch_scc1 POLLE_49
    s_cbranch_vccnz POLL_48
POLLE_49:
WAIT_47:
    s_barrier
    buffer_load_dwordx4 v[96:99], v1, s[8:11], s22 offen offset:0 sc1
    buffer_load_dwordx4 v[100:103], v1, s[8:11], s22 offen offset:1024 sc1
    buffer_load_dwordx4 v[16:19], v1, s[8:11], s20 offen offset:0 sc1
    buffer_load_dwordx4 v[20:23], v1, s[8:11], s20 offen offset:1024 sc1
    buffer_load_dwordx4 v[24:27], v1, s[8:11], s20 offen offset:2048 sc1
    buffer_load_dwordx4 v[28:31], v1, s[8:11], s20 offen offset:3072 sc1
    s_add_u32 s19, s20, 4096
    buffer_load_dwordx4 v[32:35], v1, s[8:11], s19 offen offset:0 sc1
    buffer_load_dwordx4 v[36:39], v1, s[8:11], s19 offen offset:1024 sc1
    buffer_load_dwordx4 v[40:43], v1, s[8:11], s19 offen offset:2048 sc1
    buffer_load_dwordx4 v[44:47], v1, s[8:11], s19 offen offset:3072 sc1
    s_waitcnt vmcnt(8)
    v_add_f32 v96, v96, v100
    v_add_f32 v97, v97, v101
    v_add_f32 v98, v98, v102
    v_add_f32 v99, v99, v103
    v_mov_b32 v100, v96
    v_mov_b32 v101, v97
    v_mov_b32 v102, v98
    v_mov_b32 v103, v99
    v_permlane16_swap_b32 v96, v100
    v_permlane16_swap_b32 v97, v101
    v_permlane16_swap_b32 v98, v102
    v_permlane16_swap_b32 v99, v103
    v_add_f32 v96, v96, v100
    v_add_f32 v97, v97, v101
    v_add_f32 v98, v98, v102
    v_add_f32 v99, v99, v103
    ds_write_b128 v104, v[96:99]
    s_cmp_eq_u32 s63, 0
    s_cbranch_scc1 QKV_kv
    s_waitcnt vmcnt(7)
    v_mfma_f32_32x32x16_bf16 v[48:63], v[156:159], v[16:19], 0
    s_waitcnt vmcnt(6)
    v_mfma_f32_32x32x16_bf16 v[48:63], v[160:163], v[20:23], v[48:63]
    s_waitcnt vmcnt(5)
    v_mfma_f32_32x32x16_bf16 v[48:63], v[164:167], v[24:27], v[48:63]
    s_waitcnt vmcnt(4)
    v_mfma_f32_32x32x16_bf16 v[48:63], v[168:171], v[28:31], v[48:63]
    s_waitcnt vmcnt(3)
    v_mfma_f32_32x32x16_bf16 v[48:63], v[172:175], v[32:35], v[48:63]
    s_waitcnt vmcnt(2)
    v_mfma_f32_32x32x16_bf16 v[48:63], v[176:179], v[36:39], v[48:63]
    s_waitcnt vmcnt(1)
    v_mfma_f32_32x32x16_bf16 v[48:63], v[180:183], v[40:43], v[48:63]
    s_waitcnt vmcnt(0)
    v_mfma_f32_32x32x16_bf16 v[48:63], v[184:187], v[44:47], v[48:63]
    buffer_load_dwordx4 v[188:191], v1, s[8:11], s21 offen offset:0
    buffer_load_dwordx4 v[192:195], v1, s[8:11], s21 offen offset:1024
    buffer_load_dwordx4 v[196:199], v1, s[8:11], s21 offen offset:2048
    buffer_load_dwordx4 v[200:203], v1, s[8:11], s21 offen offset:3072
    s_add_u32 s19, s21, 4096
    buffer_load_dwordx4 v[204:207], v1, s[8:11], s19 offen offset:0
    buffer_load_dwordx4 v[208:211], v1, s[8:11], s19 offen offset:1024
    buffer_load_dwordx4 v[212:215], v1, s[8:11], s19 offen offset:2048
    buffer_load_dwordx4 v[216:219], v1, s[8:11], s19 offen offset:3072
    s_cmp_eq_u32 s64, 0
    s_cbranch_scc1 NKB_51
    s_waitcnt lgkmcnt(0)
    s_barrier
NKB_51:
    s_waitcnt vmcnt(7)
    v_mfma_f32_32x32x16_bf16 v[64:79], v[188:191], v[16:19], 0
    s_waitcnt vmcnt(6)
    v_mfma_f32_32x32x16_bf16 v[64:79], v[192:195], v[20:23], v[64:79]
    s_waitcnt vmcnt(5)
    v_mfma_f32_32x32x16_bf16 v[64:79], v[196:199], v[24:27], v[64:79]
    s_waitcnt vmcnt(4)
    v_mfma_f32_32x32x16_bf16 v[64:79], v[200:203], v[28:31], v[64:79]
    s_waitcnt vmcnt(3)
    v_mfma_f32_32x32x16_bf16 v[64:79], v[204:207], v[32:35], v[64:79]
    s_waitcnt vmcnt(2)
    v_mfma_f32_32x32x16_bf16 v[64:79], v[208:211], v[36:39], v[64:79]
    s_waitcnt vmcnt(1)
    v_mfma_f32_32x32x16_bf16 v[64:79], v[212:215], v[40:43], v[64:79]
    s_waitcnt vmcnt(0)
    v_mfma_f32_32x32x16_bf16 v[64:79], v[216:219], v[44:47], v[64:79]
    s_branch QKV_mmw
DN_final:
    v_and_b32 v2, 31, v0
    v_lshlrev_b32 v2, 10, v2
    v_bfe_u32 v3, v0, 5, 1
    v_lshl_add_u32 v2, v3, 4, v2
    s_lshl_b32 s17, s62, 15
    s_bfe_u32 s18, s61, 0x5000a
    s_lshl_b32 s18, s18, 5
    s_add_u32 s17, s17, s18
    buffer_store_dwordx4 v[4:7], v2, s[24:27], s17 offen
L_exit:
    s_endpgm
ST_slow_1:
    buffer_store_dword v2, v3, s[8:11], s17 offen sc1
    s_branch ST_done_2
ST_slow_3:
    buffer_store_dword v2, v3, s[8:11], s17 offen sc1
    s_branch ST_done_4
ATT_ewq:
    s_lshr_b32 s17, s28, 5
    s_lshl_b32 s18, s17, 10
    s_add_u32 s19, s39, s18
    s_lshl_b32 s20, s3, 13
    s_add_u32 s20, s20, s18
    s_add_u32 s20, s20, 1048576
    s_and_b32 s18, s28, 7
    s_lshl_b32 s18, s18, 3
    s_add_u32 s18, s18, s3
    s_cmp_lt_u32 s18, 4
    s_cselect_b32 s20, s20, 1879048192
    s_cmp_lg_u32 s17, 0
    s_cbranch_scc1 ATT_ewq1
    buffer_store_dwordx4 v[156:159], v1, s[8:11], s19 offen sc1
    buffer_store_dwordx4 v[220:223], v1, s[8:11], s20 offen sc1
    s_branch ATT_ewqd
ATT_ewq1:
    s_cmp_lg_u32 s17, 1
    s_cbranch_scc1 ATT_ewq2
    buffer_store_dwordx4 v[160:163], v1, s[8:11], s19 offen sc1
    buffer_store_dwordx4 v[224:227], v1, s[8:11], s20 offen sc1
    s_branch ATT_ewqd
ATT_ewq2:
    s_cmp_lg_u32 s17, 2
    s_cbranch_scc1 ATT_ewq3
    buffer_store_dwordx4 v[164:167], v1, s[8:11], s19 offen sc1
    buffer_store_dwordx4 v[228:231], v1, s[8:11], s20 offen sc1
    s_branch ATT_ewqd
ATT_ewq3:
    s_cmp_lg_u32 s17, 3
    s_cbranch_scc1 ATT_ewq4
    buffer_store_dwordx4 v[168:171], v1, s[8:11], s19 offen sc1
    buffer_store_dwordx4 v[232:235], v1, s[8:11], s20 offen sc1
    s_branch ATT_ewqd
ATT_ewq4:
    s_cmp_lg_u32 s17, 4
    s_cbranch_scc1 ATT_ewq5
    buffer_store_dwordx4 v[172:175], v1, s[8:11], s19 offen sc1
    buffer_store_dwordx4 v[236:239], v1, s[8:11], s20 offen sc1
    s_branch ATT_ewqd
ATT_ewq5:
    s_cmp_lg_u32 s17, 5
    s_cbranch_scc1 ATT_ewq6
    buffer_store_dwordx4 v[176:179], v1, s[8:11], s19 offen sc1
    buffer_store_dwordx4 v[240:243], v1, s[8:11], s20 offen sc1
    s_branch ATT_ewqd
ATT_ewq6:
    s_cmp_lg_u32 s17, 6
    s_cbranch_scc1 ATT_ewq7
    buffer_store_dwordx4 v[180:183], v1, s[8:11], s19 offen sc1
    buffer_store_dwordx4 v[244:247], v1, s[8:11], s20 offen sc1
    s_branch ATT_ewqd
ATT_ewq7:
    buffer_store_dwordx4 v[184:187], v1, s[8:11], s19 offen sc1
    buffer_store_dwordx4 v[248:251], v1, s[8:11], s20 offen sc1
    s_branch ATT_ewqd
ATT_k_s:
    s_mov_b32 s18, 0
ATT_k_s1:
    buffer_load_dwordx4 v[116:119], v120, s[8:11], s60 offen offset:0 sc1
    s_waitcnt vmcnt(0)
    v_min_u32 v116, v116, v117
    v_min3_u32 v116, v116, v118, v119
    v_cmp_gt_u32 vcc, s32, v116
    s_nop 0
    s_cbranch_vccz ATT_k_ok
    s_add_u32 s18, s18, 1
    s_cmp_gt_u32 s18, 200000
    s_cbranch_scc1 ATT_k_ok
    s_sleep 2
    s_branch ATT_k_s1
ATT_p_s:
    s_mov_b32 s18, 0
ATT_p_s1:
    buffer_load_dwordx4 v[116:119], v121, s[8:11], s60 offen offset:32 sc1
    s_waitcnt vmcnt(0)
    v_min_u32 v116, v116, v117
    v_min3_u32 v116, v116, v118, v119
    v_cmp_gt_u32 vcc, s32, v116
    s_nop 0
    s_cbranch_vccz ATT_p_ok
    s_add_u32 s18, s18, 1
    s_cmp_gt_u32 s18, 200000
    s_cbranch_scc1 ATT_p_ok
    s_sleep 2
    s_branch ATT_p_s1
ATT_fb:
    s_add_u32 s17, s31, 2097152
    v_mov_b32 v14, 0xff800000
    s_mov_b32 s21, 0
ATT_fb1:
    s_add_u32 s15, s17, s21
    buffer_load_dwordx4 v[48:51], v1, s[8:11], s15 offen sc1
    s_waitcnt vmcnt(0)
    v_mfma_f32_32x32x16_bf16 v[16:31], v[48:51], v[4:7], 0
    s_nop 11
    v_max3_f32 v14, v14, v16, v17
    v_max3_f32 v14, v14, v18, v19
    v_max3_f32 v14, v14, v20, v21
    v_max3_f32 v14, v14, v22, v23
    v_max3_f32 v14, v14, v24, v25
    v_max3_f32 v14, v14, v26, v27
    v_max3_f32 v14, v14, v28, v29
    v_max3_f32 v14, v14, v30, v31
    s_add_u32 s21, s21, 1024
    s_cmp_lt_u32 s21, 65536
    s_cbranch_scc1 ATT_fb1
    v_mov_b32 v15, v14
    s_nop 1
    v_permlane32_swap_b32 v14, v15
    v_max_f32 v14, v14, v15
    v_sub_f32 v32, 0, v14
    v_sub_f32 v33, 0, v14
    v_sub_f32 v34, 0, v14
    v_sub_f32 v35, 0, v14
    v_sub_f32 v36, 0, v14
    v_sub_f32 v37, 0, v14
    v_sub_f32 v38, 0, v14
    v_sub_f32 v39, 0, v14
    v_sub_f32 v40, 0, v14
    v_sub_f32 v41, 0, v14
    v_sub_f32 v42, 0, v14
    v_sub_f32 v43, 0, v14
    v_sub_f32 v44, 0, v14
    v_sub_f32 v45, 0, v14
    v_sub_f32 v46, 0, v14
    v_sub_f32 v47, 0, v14
    v_mov_b32 v64, 0
    v_mov_b32 v65, 0
    v_mov_b32 v66, 0
    v_mov_b32 v67, 0
    v_mov_b32 v68, 0
    v_mov_b32 v69, 0
    v_mov_b32 v70, 0
    v_mov_b32 v71, 0
    v_mov_b32 v72, 0
    v_mov_b32 v73, 0
    v_mov_b32 v74, 0
    v_mov_b32 v75, 0
    v_mov_b32 v76, 0
    v_mov_b32 v77, 0
    v_mov_b32 v78, 0
    v_mov_b32 v79, 0
    v_mov_b32 v52, 0x3f803f80
    v_mov_b32 v53, 0x3f803f80
    v_mov_b32 v54, 0x3f803f80
    v_mov_b32 v55, 0x3f803f80
    v_mov_b32 v56, 0x3f803f80
    v_mov_b32 v57, 0x3f803f80
    v_mov_b32 v58, 0x3f803f80
    v_mov_b32 v59, 0x3f803f80
    s_mov_b32 s21, 0
    s_mov_b32 s22, 0x0000ffff
    s_mov_b32 s23, 0x0000ffff
ATT_fb2:
    s_add_u32 s15, s17, s21
    s_add_u32 s16, s15, 65536
    buffer_load_dwordx4 v[48:51], v1, s[8:11], s15 offen sc1
    s_mov_b64 exec, s[22:23]
    buffer_load_dwordx4 v[52:55], v10, s[8:11], s16 offen sc1
    buffer_load_dwordx4 v[56:59], v10, s[8:11], s16 offen offset:512 sc1
    s_mov_b64 exec, -1
    s_waitcnt vmcnt(0)
    v_mfma_f32_32x32x16_bf16 v[16:31], v[48:51], v[4:7], v[32:47]
    s_nop 11
    v_exp_f32 v16, v16
    v_exp_f32 v17, v17
    v_exp_f32 v18, v18
    v_exp_f32 v19, v19
    v_exp_f32 v20, v20
    v_exp_f32 v21, v21
    v_exp_f32 v22, v22
    v_exp_f32 v23, v23
    v_exp_f32 v24, v24
    v_exp_f32 v25, v25
    v_exp_f32 v26, v26
    v_exp_f32 v27, v27
    v_exp_f32 v28, v28
    v_exp_f32 v29, v29
    v_exp_f32 v30, v30
    v_exp_f32 v31, v31
    v_cvt_pk_bf16_f32 v16, v16, v17
    v_cvt_pk_bf16_f32 v17, v18, v19
    v_cvt_pk_bf16_f32 v18, v20, v21
    v_cvt_pk_bf16_f32 v19, v22, v23
    v_cvt_pk_bf16_f32 v24, v24, v25
    v_cvt_pk_bf16_f32 v25, v26, v27
    v_cvt_pk_bf16_f32 v26, v28, v29
    v_cvt_pk_bf16_f32 v27, v30, v31
    v_mfma_f32_32x32x16_bf16 v[64:79], v[52:55], v[16:19], v[64:79]
    s_nop 0
    v_mfma_f32_32x32x16_bf16 v[64:79], v[56:59], v[24:27], v[64:79]
    s_nop 7
    s_add_u32 s21, s21, 1024
    s_cmp_lt_u32 s21, 65536
    s_cbranch_scc1 ATT_fb2
    s_nop 7
    s_branch ATT_ok
ST_slow_9:
    buffer_store_dwordx4 v[80:83], v1, s[8:11], s21 offen sc1
    s_branch ST_done_10
ST_slow_12:
    buffer_store_dword v2, v3, s[8:11], s30 offen sc1
    s_branch ST_done_13
ST_slow_18:
    buffer_store_dwordx4 v[252:255], v1, s[8:11], s21 offen sc1
    s_branch ST_done_19
ST_slow_20:
    buffer_store_dwordx2 v[4:5], v7, s[8:11], s22 offen sc1
    s_branch ST_done_21
ST_slow_23:
    buffer_store_dword v2, v3, s[8:11], s30 offen sc1
    s_branch ST_done_24
ST_slow_25:
    buffer_store_dwordx4 v[20:23], v14, s[8:11], s58 offen offset:0 sc1
    s_branch ST_done_26
ST_slow_27:
    buffer_store_dwordx4 v[36:39], v14, s[8:11], s58 offen offset:1024 sc1
    s_branch ST_done_28
ST_slow_29:
    buffer_store_dwordx4 v[52:55], v14, s[8:11], s14 offen offset:0 sc1
    s_branch ST_done_30
ST_slow_31:
    buffer_store_dwordx4 v[68:71], v14, s[8:11], s14 offen offset:1024 sc1
    s_branch ST_done_32
GU_loader:
    s_setprio 3
    s_lshr_b32 s15, s28, 4
    s_lshl_b32 s15, s15, 17
    s_add_u32 s15, s15, s35
    s_add_u32 s15, s15, 4194304
    s_and_b32 s18, s30, 0xffffffc0
    v_and_b32 v2, 15, v0
    v_lshlrev_b32 v2, 2, v2
    s_mov_b32 s19, 0
POLL_52:
    buffer_load_dword v3, v2, s[8:11], s18 offen sc1
    s_add_u32 s19, s19, 1
    s_waitcnt vmcnt(0)
    v_cmp_gt_u32 vcc, s32, v3
    s_cmp_gt_u32 s19, 200000
    s_cbranch_scc1 POLLE_53
    s_cbranch_vccnz POLL_52
POLLE_53:
    s_mov_b32 m0, 0
    s_add_u32 s17, s15, 0
    buffer_load_dwordx4 v1, s[8:11], s17 offen offset:0 sc1 lds
    buffer_load_dwordx4 v1, s[8:11], s17 offen offset:1024 sc1 lds
    buffer_load_dwordx4 v1, s[8:11], s17 offen offset:2048 sc1 lds
    buffer_load_dwordx4 v1, s[8:11], s17 offen offset:3072 sc1 lds
    s_mov_b32 m0, 32768
    s_add_u32 s17, s15, 32768
    buffer_load_dwordx4 v1, s[8:11], s17 offen offset:0 sc1 lds
    buffer_load_dwordx4 v1, s[8:11], s17 offen offset:1024 sc1 lds
    buffer_load_dwordx4 v1, s[8:11], s17 offen offset:2048 sc1 lds
    buffer_load_dwordx4 v1, s[8:11], s17 offen offset:3072 sc1 lds
    s_mov_b32 m0, 65536
    s_add_u32 s17, s15, 65536
    buffer_load_dwordx4 v1, s[8:11], s17 offen offset:0 sc1 lds
    buffer_load_dwordx4 v1, s[8:11], s17 offen offset:1024 sc1 lds
    buffer_load_dwordx4 v1, s[8:11], s17 offen offset:2048 sc1 lds
    buffer_load_dwordx4 v1, s[8:11], s17 offen offset:3072 sc1 lds
    s_mov_b32 m0, 98304
    s_add_u32 s17, s15, 98304
    buffer_load_dwordx4 v1, s[8:11], s17 offen offset:0 sc1 lds
    buffer_load_dwordx4 v1, s[8:11], s17 offen offset:1024 sc1 lds
    buffer_load_dwordx4 v1, s[8:11], s17 offen offset:2048 sc1 lds
    buffer_load_dwordx4 v1, s[8:11], s17 offen offset:3072 sc1 lds
    s_mov_b32 m0, 4096
    s_add_u32 s17, s15, 4096
    buffer_load_dwordx4 v1, s[8:11], s17 offen offset:0 sc1 lds
    buffer_load_dwordx4 v1, s[8:11], s17 offen offset:1024 sc1 lds
    buffer_load_dwordx4 v1, s[8:11], s17 offen offset:2048 sc1 lds
    buffer_load_dwordx4 v1, s[8:11], s17 offen offset:3072 sc1 lds
    s_mov_b32 m0, 36864
    s_add_u32 s17, s15, 36864
    buffer_load_dwordx4 v1, s[8:11], s17 offen offset:0 sc1 lds
    buffer_load_dwordx4 v1, s[8:11], s17 offen offset:1024 sc1 lds
    buffer_load_dwordx4 v1, s[8:11], s17 offen offset:2048 sc1 lds
    buffer_load_dwordx4 v1, s[8:11], s17 offen offset:3072 sc1 lds
    s_mov_b32 m0, 69632
    s_add_u32 s17, s15, 69632
    buffer_load_dwordx4 v1, s[8:11], s17 offen offset:0 sc1 lds
    buffer_load_dwordx4 v1, s[8:11], s17 offen offset:1024 sc1 lds
    buffer_load_dwordx4 v1, s[8:11], s17 offen offset:2048 sc1 lds
    buffer_load_dwordx4 v1, s[8:11], s17 offen offset:3072 sc1 lds
    s_mov_b32 m0, 102400
    s_add_u32 s17, s15, 102400
    buffer_load_dwordx4 v1, s[8:11], s17 offen offset:0 sc1 lds
    buffer_load_dwordx4 v1, s[8:11], s17 offen offset:1024 sc1 lds
    buffer_load_dwordx4 v1, s[8:11], s17 offen offset:2048 sc1 lds
    buffer_load_dwordx4 v1, s[8:11], s17 offen offset:3072 sc1 lds
    s_waitcnt vmcnt(16)
    s_barrier
    s_mov_b32 m0, 8192
    s_add_u32 s17, s15, 8192
    buffer_load_dwordx4 v1, s[8:11], s17 offen offset:0 sc1 lds
    buffer_load_dwordx4 v1, s[8:11], s17 offen offset:1024 sc1 lds
    buffer_load_dwordx4 v1, s[8:11], s17 offen offset:2048 sc1 lds
    buffer_load_dwordx4 v1, s[8:11], s17 offen offset:3072 sc1 lds
    s_mov_b32 m0, 40960
    s_add_u32 s17, s15, 40960
    buffer_load_dwordx4 v1, s[8:11], s17 offen offset:0 sc1 lds
    buffer_load_dwordx4 v1, s[8:11], s17 offen offset:1024 sc1 lds
    buffer_load_dwordx4 v1, s[8:11], s17 offen offset:2048 sc1 lds
    buffer_load_dwordx4 v1, s[8:11], s17 offen offset:3072 sc1 lds
    s_mov_b32 m0, 73728
    s_add_u32 s17, s15, 73728
    buffer_load_dwordx4 v1, s[8:11], s17 offen offset:0 sc1 lds
    buffer_load_dwordx4 v1, s[8:11], s17 offen offset:1024 sc1 lds
    buffer_load_dwordx4 v1, s[8:11], s17 offen offset:2048 sc1 lds
    buffer_load_dwordx4 v1, s[8:11], s17 offen offset:3072 sc1 lds
    s_mov_b32 m0, 106496
    s_add_u32 s17, s15, 106496
    buffer_load_dwordx4 v1, s[8:11], s17 offen offset:0 sc1 lds
    buffer_load_dwordx4 v1, s[8:11], s17 offen offset:1024 sc1 lds
    buffer_load_dwordx4 v1, s[8:11], s17 offen offset:2048 sc1 lds
    buffer_load_dwordx4 v1, s[8:11], s17 offen offset:3072 sc1 lds
    s_mov_b32 m0, 12288
    s_add_u32 s17, s15, 12288
    buffer_load_dwordx4 v1, s[8:11], s17 offen offset:0 sc1 lds
    buffer_load_dwordx4 v1, s[8:11], s17 offen offset:1024 sc1 lds
    buffer_load_dwordx4 v1, s[8:11], s17 offen offset:2048 sc1 lds
    buffer_load_dwordx4 v1, s[8:11], s17 offen offset:3072 sc1 lds
    s_mov_b32 m0, 45056
    s_add_u32 s17, s15, 45056
    buffer_load_dwordx4 v1, s[8:11], s17 offen offset:0 sc1 lds
    buffer_load_dwordx4 v1, s[8:11], s17 offen offset:1024 sc1 lds
    buffer_load_dwordx4 v1, s[8:11], s17 offen offset:2048 sc1 lds
    buffer_load_dwordx4 v1, s[8:11], s17 offen offset:3072 sc1 lds
    s_mov_b32 m0, 77824
    s_add_u32 s17, s15, 77824
    buffer_load_dwordx4 v1, s[8:11], s17 offen offset:0 sc1 lds
    buffer_load_dwordx4 v1, s[8:11], s17 offen offset:1024 sc1 lds
    buffer_load_dwordx4 v1, s[8:11], s17 offen offset:2048 sc1 lds
    buffer_load_dwordx4 v1, s[8:11], s17 offen offset:3072 sc1 lds
    s_mov_b32 m0, 110592
    s_add_u32 s17, s15, 110592
    buffer_load_dwordx4 v1, s[8:11], s17 offen offset:0 sc1 lds
    buffer_load_dwordx4 v1, s[8:11], s17 offen offset:1024 sc1 lds
    buffer_load_dwordx4 v1, s[8:11], s17 offen offset:2048 sc1 lds
    buffer_load_dwordx4 v1, s[8:11], s17 offen offset:3072 sc1 lds
    s_waitcnt vmcnt(32)
    s_barrier
    s_mov_b32 m0, 16384
    s_add_u32 s17, s15, 16384
    buffer_load_dwordx4 v1, s[8:11], s17 offen offset:0 sc1 lds
    buffer_load_dwordx4 v1, s[8:11], s17 offen offset:1024 sc1 lds
    buffer_load_dwordx4 v1, s[8:11], s17 offen offset:2048 sc1 lds
    buffer_load_dwordx4 v1, s[8:11], s17 offen offset:3072 sc1 lds
    s_mov_b32 m0, 49152
    s_add_u32 s17, s15, 49152
    buffer_load_dwordx4 v1, s[8:11], s17 offen offset:0 sc1 lds
    buffer_load_dwordx4 v1, s[8:11], s17 offen offset:1024 sc1 lds
    buffer_load_dwordx4 v1, s[8:11], s17 offen offset:2048 sc1 lds
    buffer_load_dwordx4 v1, s[8:11], s17 offen offset:3072 sc1 lds
    s_mov_b32 m0, 81920
    s_add_u32 s17, s15, 81920
    buffer_load_dwordx4 v1, s[8:11], s17 offen offset:0 sc1 lds
    buffer_load_dwordx4 v1, s[8:11], s17 offen offset:1024 sc1 lds
    buffer_load_dwordx4 v1, s[8:11], s17 offen offset:2048 sc1 lds
    buffer_load_dwordx4 v1, s[8:11], s17 offen offset:3072 sc1 lds
    s_mov_b32 m0, 114688
    s_add_u32 s17, s15, 114688
    buffer_load_dwordx4 v1, s[8:11], s17 offen offset:0 sc1 lds
    buffer_load_dwordx4 v1, s[8:11], s17 offen offset:1024 sc1 lds
    buffer_load_dwordx4 v1, s[8:11], s17 offen offset:2048 sc1 lds
    buffer_load_dwordx4 v1, s[8:11], s17 offen offset:3072 sc1 lds
    s_waitcnt vmcnt(32)
    s_mov_b32 m0, 20480
    s_add_u32 s17, s15, 20480
    buffer_load_dwordx4 v1, s[8:11], s17 offen offset:0 sc1 lds
    buffer_load_dwordx4 v1, s[8:11], s17 offen offset:1024 sc1 lds
    buffer_load_dwordx4 v1, s[8:11], s17 offen offset:2048 sc1 lds
    buffer_load_dwordx4 v1, s[8:11], s17 offen offset:3072 sc1 lds
    s_mov_b32 m0, 53248
    s_add_u32 s17, s15, 53248
    buffer_load_dwordx4 v1, s[8:11], s17 offen offset:0 sc1 lds
    buffer_load_dwordx4 v1, s[8:11], s17 offen offset:1024 sc1 lds
    buffer_load_dwordx4 v1, s[8:11], s17 offen offset:2048 sc1 lds
    buffer_load_dwordx4 v1, s[8:11], s17 offen offset:3072 sc1 lds
    s_mov_b32 m0, 86016
    s_add_u32 s17, s15, 86016
    buffer_load_dwordx4 v1, s[8:11], s17 offen offset:0 sc1 lds
    buffer_load_dwordx4 v1, s[8:11], s17 offen offset:1024 sc1 lds
    buffer_load_dwordx4 v1, s[8:11], s17 offen offset:2048 sc1 lds
    buffer_load_dwordx4 v1, s[8:11], s17 offen offset:3072 sc1 lds
    s_mov_b32 m0, 118784
    s_add_u32 s17, s15, 118784
    buffer_load_dwordx4 v1, s[8:11], s17 offen offset:0 sc1 lds
    buffer_load_dwordx4 v1, s[8:11], s17 offen offset:1024 sc1 lds
    buffer_load_dwordx4 v1, s[8:11], s17 offen offset:2048 sc1 lds
    buffer_load_dwordx4 v1, s[8:11], s17 offen offset:3072 sc1 lds
    s_waitcnt vmcnt(32)
    s_barrier
    s_mov_b32 m0, 24576
    s_add_u32 s17, s15, 24576
    buffer_load_dwordx4 v1, s[8:11], s17 offen offset:0 sc1 lds
    buffer_load_dwordx4 v1, s[8:11], s17 offen offset:1024 sc1 lds
    buffer_load_dwordx4 v1, s[8:11], s17 offen offset:2048 sc1 lds
    buffer_load_dwordx4 v1, s[8:11], s17 offen offset:3072 sc1 lds
    s_mov_b32 m0, 57344
    s_add_u32 s17, s15, 57344
    buffer_load_dwordx4 v1, s[8:11], s17 offen offset:0 sc1 lds
    buffer_load_dwordx4 v1, s[8:11], s17 offen offset:1024 sc1 lds
    buffer_load_dwordx4 v1, s[8:11], s17 offen offset:2048 sc1 lds
    buffer_load_dwordx4 v1, s[8:11], s17 offen offset:3072 sc1 lds
    s_mov_b32 m0, 90112
    s_add_u32 s17, s15, 90112
    buffer_load_dwordx4 v1, s[8:11], s17 offen offset:0 sc1 lds
    buffer_load_dwordx4 v1, s[8:11], s17 offen offset:1024 sc1 lds
    buffer_load_dwordx4 v1, s[8:11], s17 offen offset:2048 sc1 lds
    buffer_load_dwordx4 v1, s[8:11], s17 offen offset:3072 sc1 lds
    s_mov_b32 m0, 122880
    s_add_u32 s17, s15, 122880
    buffer_load_dwordx4 v1, s[8:11], s17 offen offset:0 sc1 lds
    buffer_load_dwordx4 v1, s[8:11], s17 offen offset:1024 sc1 lds
    buffer_load_dwordx4 v1, s[8:11], s17 offen offset:2048 sc1 lds
    buffer_load_dwordx4 v1, s[8:11], s17 offen offset:3072 sc1 lds
    s_waitcnt vmcnt(32)
    s_mov_b32 m0, 28672
    s_add_u32 s17, s15, 28672
    buffer_load_dwordx4 v1, s[8:11], s17 offen offset:0 sc1 lds
    buffer_load_dwordx4 v1, s[8:11], s17 offen offset:1024 sc1 lds
    buffer_load_dwordx4 v1, s[8:11], s17 offen offset:2048 sc1 lds
    buffer_load_dwordx4 v1, s[8:11], s17 offen offset:3072 sc1 lds
    s_mov_b32 m0, 61440
    s_add_u32 s17, s15, 61440
    buffer_load_dwordx4 v1, s[8:11], s17 offen offset:0 sc1 lds
    buffer_load_dwordx4 v1, s[8:11], s17 offen offset:1024 sc1 lds
    buffer_load_dwordx4 v1, s[8:11], s17 offen offset:2048 sc1 lds
    buffer_load_dwordx4 v1, s[8:11], s17 offen offset:3072 sc1 lds
    s_mov_b32 m0, 94208
    s_add_u32 s17, s15, 94208
    buffer_load_dwordx4 v1, s[8:11], s17 offen offset:0 sc1 lds
    buffer_load_dwordx4 v1, s[8:11], s17 offen offset:1024 sc1 lds
    buffer_load_dwordx4 v1, s[8:11], s17 offen offset:2048 sc1 lds
    buffer_load_dwordx4 v1, s[8:11], s17 offen offset:3072 sc1 lds
    s_mov_b32 m0, 126976
    s_add_u32 s17, s15, 126976
    buffer_load_dwordx4 v1, s[8:11], s17 offen offset:0 sc1 lds
    buffer_load_dwordx4 v1, s[8:11], s17 offen offset:1024 sc1 lds
    buffer_load_dwordx4 v1, s[8:11], s17 offen offset:2048 sc1 lds
    buffer_load_dwordx4 v1, s[8:11], s17 offen offset:3072 sc1 lds
    s_setprio 0
    s_lshr_b32 s16, s28, 4
    s_lshl_b32 s16, s16, 15
    s_add_u32 s16, s16, s35
    s_add_u32 s16, s16, 6291456
    s_waitcnt vmcnt(0)
    s_barrier
    v_and_b32 v2, 15, v0
    v_lshlrev_b32 v2, 5, v2
    v_add_u32 v2, 135168, v2
    buffer_load_dwordx4 v[16:19], v1, s[8:11], s16 offen offset:0 sc1
    buffer_load_dwordx4 v[20:23], v1, s[8:11], s16 offen offset:1024 sc1
    buffer_load_dwordx4 v[24:27], v1, s[8:11], s16 offen offset:2048 sc1
    buffer_load_dwordx4 v[28:31], v1, s[8:11], s16 offen offset:3072 sc1
    s_add_u32 s19, s16, 4096
    buffer_load_dwordx4 v[32:35], v1, s[8:11], s19 offen offset:0 sc1
    buffer_load_dwordx4 v[36:39], v1, s[8:11], s19 offen offset:1024 sc1
    buffer_load_dwordx4 v[40:43], v1, s[8:11], s19 offen offset:2048 sc1
    buffer_load_dwordx4 v[44:47], v1, s[8:11], s19 offen offset:3072 sc1
    s_add_u32 s19, s16, 8192
    buffer_load_dwordx4 v[48:51], v1, s[8:11], s19 offen offset:0 sc1
    buffer_load_dwordx4 v[52:55], v1, s[8:11], s19 offen offset:1024 sc1
    buffer_load_dwordx4 v[56:59], v1, s[8:11], s19 offen offset:2048 sc1
    buffer_load_dwordx4 v[60:63], v1, s[8:11], s19 offen offset:3072 sc1
    s_add_u32 s19, s16, 12288
    buffer_load_dwordx4 v[64:67], v1, s[8:11], s19 offen offset:0 sc1
    buffer_load_dwordx4 v[68:71], v1, s[8:11], s19 offen offset:1024 sc1
    buffer_load_dwordx4 v[72:75], v1, s[8:11], s19 offen offset:2048 sc1
    buffer_load_dwordx4 v[76:79], v1, s[8:11], s19 offen offset:3072 sc1
    s_add_u32 s19, s16, 16384
    buffer_load_dwordx4 v[80:83], v1, s[8:11], s19 offen offset:0 sc1
    buffer_load_dwordx4 v[84:87], v1, s[8:11], s19 offen offset:1024 sc1
    buffer_load_dwordx4 v[88:91], v1, s[8:11], s19 offen offset:2048 sc1
    buffer_load_dwordx4 v[92:95], v1, s[8:11], s19 offen offset:3072 sc1
    s_add_u32 s19, s16, 20480
    buffer_load_dwordx4 v[96:99], v1, s[8:11], s19 offen offset:0 sc1
    buffer_load_dwordx4 v[100:103], v1, s[8:11], s19 offen offset:1024 sc1
    buffer_load_dwordx4 v[104:107], v1, s[8:11], s19 offen offset:2048 sc1
    buffer_load_dwordx4 v[108:111], v1, s[8:11], s19 offen offset:3072 sc1
    s_waitcnt vmcnt(16)
    v_pk_add_f32 v[16:17], v[16:17], v[32:33]
    v_pk_add_f32 v[18:19], v[18:19], v[34:35]
    v_pk_add_f32 v[20:21], v[20:21], v[36:37]
    v_pk_add_f32 v[22:23], v[22:23], v[38:39]
    v_pk_add_f32 v[24:25], v[24:25], v[40:41]
    v_pk_add_f32 v[26:27], v[26:27], v[42:43]
    v_pk_add_f32 v[28:29], v[28:29], v[44:45]
    v_pk_add_f32 v[30:31], v[30:31], v[46:47]
    v_pk_add_f32 v[16:17], v[16:17], v[24:25]
    v_pk_add_f32 v[18:19], v[18:19], v[26:27]
    v_pk_add_f32 v[20:21], v[20:21], v[28:29]
    v_pk_add_f32 v[22:23], v[22:23], v[30:31]
    v_pk_add_f32 v[4:5], v[16:17], v[20:21]
    v_pk_add_f32 v[6:7], v[18:19], v[22:23]
    s_add_u32 s19, s16, 24576
    buffer_load_dwordx4 v[16:19], v1, s[8:11], s19 offen offset:0 sc1
    buffer_load_dwordx4 v[20:23], v1, s[8:11], s19 offen offset:1024 sc1
    buffer_load_dwordx4 v[24:27], v1, s[8:11], s19 offen offset:2048 sc1
    buffer_load_dwordx4 v[28:31], v1, s[8:11], s19 offen offset:3072 sc1
    s_add_u32 s19, s16, 28672
    buffer_load_dwordx4 v[32:35], v1, s[8:11], s19 offen offset:0 sc1
    buffer_load_dwordx4 v[36:39], v1, s[8:11], s19 offen offset:1024 sc1
    buffer_load_dwordx4 v[40:43], v1, s[8:11], s19 offen offset:2048 sc1
    buffer_load_dwordx4 v[44:47], v1, s[8:11], s19 offen offset:3072 sc1
    v_mov_b32 v8, v4
    v_mov_b32 v9, v5
    v_mov_b32 v10, v6
    v_mov_b32 v11, v7
    v_permlane32_swap_b32 v4, v8
    v_permlane32_swap_b32 v5, v9
    v_permlane32_swap_b32 v6, v10
    v_permlane32_swap_b32 v7, v11
    v_pk_add_f32 v[4:5], v[4:5], v[8:9]
    v_pk_add_f32 v[6:7], v[6:7], v[10:11]
    v_mov_b32 v8, v4
    v_mov_b32 v9, v5
    v_mov_b32 v10, v6
    v_mov_b32 v11, v7
    v_permlane16_swap_b32 v4, v8
    v_permlane16_swap_b32 v5, v9
    v_permlane16_swap_b32 v6, v10
    v_permlane16_swap_b32 v7, v11
    v_pk_add_f32 v[4:5], v[4:5], v[8:9]
    v_pk_add_f32 v[6:7], v[6:7], v[10:11]
    v_mul_f32 v4, 0x3b000000, v4
    v_mul_f32 v5, 0x3b000000, v5
    v_mul_f32 v6, 0x3b000000, v6
    v_mul_f32 v7, 0x3b000000, v7
    v_fma_f32 v5, -v4, v4, v5
    v_fma_f32 v7, -v6, v6, v7
    v_max_f32 v5, 0, v5
    v_max_f32 v7, 0, v7
    v_add_f32 v5, 0x3727c5ac, v5
    v_add_f32 v7, 0x3727c5ac, v7
    v_rcp_f32 v114, v5
    v_rcp_f32 v115, v5
    v_mov_b32 v112, v4
    v_mov_b32 v113, v4
    ds_write_b128 v2, v[112:115] offset:0
    v_rcp_f32 v118, v7
    v_rcp_f32 v119, v7
    v_mov_b32 v116, v6
    v_mov_b32 v117, v6
    ds_write_b128 v2, v[116:119] offset:16
    s_waitcnt vmcnt(16)
    v_pk_add_f32 v[48:49], v[48:49], v[64:65]
    v_pk_add_f32 v[50:51], v[50:51], v[66:67]
    v_pk_add_f32 v[52:53], v[52:53], v[68:69]
    v_pk_add_f32 v[54:55], v[54:55], v[70:71]
    v_pk_add_f32 v[56:57], v[56:57], v[72:73]
    v_pk_add_f32 v[58:59], v[58:59], v[74:75]
    v_pk_add_f32 v[60:61], v[60:61], v[76:77]
    v_pk_add_f32 v[62:63], v[62:63], v[78:79]
    v_pk_add_f32 v[48:49], v[48:49], v[56:57]
    v_pk_add_f32 v[50:51], v[50:51], v[58:59]
    v_pk_add_f32 v[52:53], v[52:53], v[60:61]
    v_pk_add_f32 v[54:55], v[54:55], v[62:63]
    v_pk_add_f32 v[4:5], v[48:49], v[52:53]
    v_pk_add_f32 v[6:7], v[50:51], v[54:55]
    v_mov_b32 v8, v4
    v_mov_b32 v9, v5
    v_mov_b32 v10, v6
    v_mov_b32 v11, v7
    v_permlane32_swap_b32 v4, v8
    v_permlane32_swap_b32 v5, v9
    v_permlane32_swap_b32 v6, v10
    v_permlane32_swap_b32 v7, v11
    v_pk_add_f32 v[4:5], v[4:5], v[8:9]
    v_pk_add_f32 v[6:7], v[6:7], v[10:11]
    v_mov_b32 v8, v4
    v_mov_b32 v9, v5
    v_mov_b32 v10, v6
    v_mov_b32 v11, v7
    v_permlane16_swap_b32 v4, v8
    v_permlane16_swap_b32 v5, v9
    v_permlane16_swap_b32 v6, v10
    v_permlane16_swap_b32 v7, v11
    v_pk_add_f32 v[4:5], v[4:5], v[8:9]
    v_pk_add_f32 v[6:7], v[6:7], v[10:11]
    v_mul_f32 v4, 0x3b000000, v4
    v_mul_f32 v5, 0x3b000000, v5
    v_mul_f32 v6, 0x3b000000, v6
    v_mul_f32 v7, 0x3b000000, v7
    v_fma_f32 v5, -v4, v4, v5
    v_fma_f32 v7, -v6, v6, v7
    v_max_f32 v5, 0, v5
    v_max_f32 v7, 0, v7
    v_add_f32 v5, 0x3727c5ac, v5
    v_add_f32 v7, 0x3727c5ac, v7
    v_rcp_f32 v114, v5
    v_rcp_f32 v115, v5
    v_mov_b32 v112, v4
    v_mov_b32 v113, v4
    ds_write_b128 v2, v[112:115] offset:512
    v_rcp_f32 v118, v7
    v_rcp_f32 v119, v7
    v_mov_b32 v116, v6
    v_mov_b32 v117, v6
    ds_write_b128 v2, v[116:119] offset:528
    s_waitcnt vmcnt(8)
    v_pk_add_f32 v[80:81], v[80:81], v[96:97]
    v_pk_add_f32 v[82:83], v[82:83], v[98:99]
    v_pk_add_f32 v[84:85], v[84:85], v[100:101]
    v_pk_add_f32 v[86:87], v[86:87], v[102:103]
    v_pk_add_f32 v[88:89], v[88:89], v[104:105]
    v_pk_add_f32 v[90:91], v[90:91], v[106:107]
    v_pk_add_f32 v[92:93], v[92:93], v[108:109]
    v_pk_add_f32 v[94:95], v[94:95], v[110:111]
    v_pk_add_f32 v[80:81], v[80:81], v[88:89]
    v_pk_add_f32 v[82:83], v[82:83], v[90:91]
    v_pk_add_f32 v[84:85], v[84:85], v[92:93]
    v_pk_add_f32 v[86:87], v[86:87], v[94:95]
    v_pk_add_f32 v[4:5], v[80:81], v[84:85]
    v_pk_add_f32 v[6:7], v[82:83], v[86:87]
    v_mov_b32 v8, v4
    v_mov_b32 v9, v5
    v_mov_b32 v10, v6
    v_mov_b32 v11, v7
    v_permlane32_swap_b32 v4, v8
    v_permlane32_swap_b32 v5, v9
    v_permlane32_swap_b32 v6, v10
    v_permlane32_swap_b32 v7, v11
    v_pk_add_f32 v[4:5], v[4:5], v[8:9]
    v_pk_add_f32 v[6:7], v[6:7], v[10:11]
    v_mov_b32 v8, v4
    v_mov_b32 v9, v5
    v_mov_b32 v10, v6
    v_mov_b32 v11, v7
    v_permlane16_swap_b32 v4, v8
    v_permlane16_swap_b32 v5, v9
    v_permlane16_swap_b32 v6, v10
    v_permlane16_swap_b32 v7, v11
    v_pk_add_f32 v[4:5], v[4:5], v[8:9]
    v_pk_add_f32 v[6:7], v[6:7], v[10:11]
    v_mul_f32 v4, 0x3b000000, v4
    v_mul_f32 v5, 0x3b000000, v5
    v_mul_f32 v6, 0x3b000000, v6
    v_mul_f32 v7, 0x3b000000, v7
    v_fma_f32 v5, -v4, v4, v5
    v_fma_f32 v7, -v6, v6, v7
    v_max_f32 v5, 0, v5
    v_max_f32 v7, 0, v7
    v_add_f32 v5, 0x3727c5ac, v5
    v_add_f32 v7, 0x3727c5ac, v7
    v_rcp_f32 v114, v5
    v_rcp_f32 v115, v5
    v_mov_b32 v112, v4
    v_mov_b32 v113, v4
    ds_write_b128 v2, v[112:115] offset:1024
    v_rcp_f32 v118, v7
    v_rcp_f32 v119, v7
    v_mov_b32 v116, v6
    v_mov_b32 v117, v6
    ds_write_b128 v2, v[116:119] offset:1040
    s_waitcnt vmcnt(0)
    v_pk_add_f32 v[16:17], v[16:17], v[32:33]
    v_pk_add_f32 v[18:19], v[18:19], v[34:35]
    v_pk_add_f32 v[20:21], v[20:21], v[36:37]
    v_pk_add_f32 v[22:23], v[22:23], v[38:39]
    v_pk_add_f32 v[24:25], v[24:25], v[40:41]
    v_pk_add_f32 v[26:27], v[26:27], v[42:43]
    v_pk_add_f32 v[28:29], v[28:29], v[44:45]
    v_pk_add_f32 v[30:31], v[30:31], v[46:47]
    v_pk_add_f32 v[16:17], v[16:17], v[24:25]
    v_pk_add_f32 v[18:19], v[18:19], v[26:27]
    v_pk_add_f32 v[20:21], v[20:21], v[28:29]
    v_pk_add_f32 v[22:23], v[22:23], v[30:31]
    v_pk_add_f32 v[4:5], v[16:17], v[20:21]
    v_pk_add_f32 v[6:7], v[18:19], v[22:23]
    v_mov_b32 v8, v4
    v_mov_b32 v9, v5
    v_mov_b32 v10, v6
    v_mov_b32 v11, v7
    v_permlane32_swap_b32 v4, v8
    v_permlane32_swap_b32 v5, v9
    v_permlane32_swap_b32 v6, v10
    v_permlane32_swap_b32 v7, v11
    v_pk_add_f32 v[4:5], v[4:5], v[8:9]
    v_pk_add_f32 v[6:7], v[6:7], v[10:11]
    v_mov_b32 v8, v4
    v_mov_b32 v9, v5
    v_mov_b32 v10, v6
    v_mov_b32 v11, v7
    v_permlane16_swap_b32 v4, v8
    v_permlane16_swap_b32 v5, v9
    v_permlane16_swap_b32 v6, v10
    v_permlane16_swap_b32 v7, v11
    v_pk_add_f32 v[4:5], v[4:5], v[8:9]
    v_pk_add_f32 v[6:7], v[6:7], v[10:11]
    v_mul_f32 v4, 0x3b000000, v4
    v_mul_f32 v5, 0x3b000000, v5
    v_mul_f32 v6, 0x3b000000, v6
    v_mul_f32 v7, 0x3b000000, v7
    v_fma_f32 v5, -v4, v4, v5
    v_fma_f32 v7, -v6, v6, v7
    v_max_f32 v5, 0, v5
    v_max_f32 v7, 0, v7
    v_add_f32 v5, 0x3727c5ac, v5
    v_add_f32 v7, 0x3727c5ac, v7
    v_rcp_f32 v114, v5
    v_rcp_f32 v115, v5
    v_mov_b32 v112, v4
    v_mov_b32 v113, v4
    ds_write_b128 v2, v[112:115] offset:1536
    v_rcp_f32 v118, v7
    v_rcp_f32 v119, v7
    v_mov_b32 v116, v6
    v_mov_b32 v117, v6
    ds_write_b128 v2, v[116:119] offset:1552
    s_waitcnt lgkmcnt(0)
    s_barrier
    s_branch GU_end
ST_slow_34:
    buffer_store_dword v2, v3, s[8:11], s30 offen sc1
    s_branch ST_done_35
ST_slow_40:
    buffer_store_dwordx4 v[4:7], v1, s[8:11], s20 offen sc1
    s_branch ST_done_41
ST_slow_42:
    buffer_store_dwordx2 v[8:9], v11, s[8:11], s22 offen sc1
    s_branch ST_done_43
DN_wk:
    s_and_b32 s17, s3, 3
    s_lshl_b32 s17, s17, 13
    s_add_u32 s17, s17, 1048576
    buffer_load_dwordx4 v[220:223], v1, s[8:11], s17 offen offset:0
    buffer_load_dwordx4 v[224:227], v1, s[8:11], s17 offen offset:1024
    buffer_load_dwordx4 v[228:231], v1, s[8:11], s17 offen offset:2048
    buffer_load_dwordx4 v[232:235], v1, s[8:11], s17 offen offset:3072
    s_add_u32 s19, s17, 4096
    buffer_load_dwordx4 v[236:239], v1, s[8:11], s19 offen offset:0
    buffer_load_dwordx4 v[240:243], v1, s[8:11], s19 offen offset:1024
    buffer_load_dwordx4 v[244:247], v1, s[8:11], s19 offen offset:2048
    buffer_load_dwordx4 v[248:251], v1, s[8:11], s19 offen offset:3072
    s_setprio 2
    s_branch DN_wd
ST_slow_45:
    buffer_store_dword v2, v3, s[8:11], s30 offen sc1
    s_branch ST_done_46
M_end:
.section .rodata,"a"
.p2align 6
.amdhsa_kernel interleave_layers__grouped_kv_mqa__glu_gated_bilinear__prompt_kernel
  .amdhsa_next_free_vgpr 256
  .amdhsa_next_free_sgpr 66
  .amdhsa_accum_offset 256
  .amdhsa_group_segment_fixed_size 0
  .amdhsa_kernarg_size 96
  .amdhsa_user_sgpr_count 2
  .amdhsa_user_sgpr_kernarg_segment_ptr 1
  .amdhsa_system_sgpr_workgroup_id_x 1
.end_amdhsa_kernel
```
